```python
import torch

def _softmax(x, axis=-1):
    return torch.softmax(x, dim=axis)
def _gelu(x):
    return torch.nn.functional.gelu(x, approximate="tanh")
def _silu(x):
    return torch.nn.functional.silu(x)
def _sigmoid(x):
    return torch.sigmoid(x)
def _layernorm(x, axis=-1, eps=1e-5):
    m = x.mean(dim=axis, keepdim=True)
    v = x.var(dim=axis, keepdim=True, unbiased=False)
    return (x - m) / torch.sqrt(v + eps)
def _scatter_add(tgt, idx, src, axis=0):
    return tgt.clone().index_add_(axis, idx, src)
def _segment_sum(src, seg, n):
    out = torch.zeros((n,) + src.shape[1:], dtype=src.dtype)
    return out.index_add_(0, seg, src)
def _pad(x, pw):
    flat = tuple(v for pair in reversed(pw) for v in pair)
    return torch.nn.functional.pad(x, flat)

kernel_name = 'sequential_preLN__ssm_conv_h3__glu_gated_bilinear__prompt'

def setup_inputs():

    _w = (lambda a: (lambda t: t.to(torch.bfloat16) if t.is_floating_point() else t)(torch.as_tensor(a)))
    def _A_setup():
        B, S, D = 1, 2048, 640
        ks = 4
        return {
            "q": _w((lambda *s: torch.randn(*s, dtype=torch.bfloat16) * 0.05)(B, S, D)),
            "k": _w((lambda *s: torch.randn(*s, dtype=torch.bfloat16) * 0.2)(B, S, D)),
            "v": _w((lambda *s: torch.randn(*s, dtype=torch.bfloat16) * 0.2)(B, S, D)),
            "shift_k": _w((lambda *s: torch.randn(*s, dtype=torch.bfloat16) * 0.2)(D, ks) * 0.5),
            "ssm_k": _w((lambda *s: torch.randn(*s, dtype=torch.bfloat16) * 0.4)(D, S) * (1.0 / S ** 0.5)),
            "ssm_D": _w((lambda *s: torch.randn(*s, dtype=torch.bfloat16) * 0.2)(D)),
        }
    _A_in = _A_setup()

    def _B_setup():
        B, S, D, F = 1, 2048, 640, 1536
        return {
            "x": _w((lambda *s: torch.randn(*s, dtype=torch.bfloat16) * 0.05)(B, S, D)),
            "w_gate": _w((lambda *s: torch.randn(*s, dtype=torch.bfloat16) * 0.2)(D, F) * (D ** -0.5)),
            "w_up": _w((lambda *s: torch.randn(*s, dtype=torch.bfloat16) * 0.2)(D, F) * (D ** -0.5)),
            "w_down": _w((lambda *s: torch.randn(*s, dtype=torch.bfloat16) * 0.2)(F, D) * (F ** -0.5)),
        }
    _B_in = _B_setup()

    return {
        "A_q": _A_in["q"],
        "A_k": _A_in["k"],
        "A_v": _A_in["v"],
        "A_shift_k": _A_in["shift_k"],
        "A_ssm_k": _A_in["ssm_k"],
        "A_ssm_D": _A_in["ssm_D"],
        "B_x": _B_in["x"],
        "B_w_gate": _B_in["w_gate"],
        "B_w_up": _B_in["w_up"],
        "B_w_down": _B_in["w_down"],
    }

def reference(A_q, A_k, A_v, A_shift_k, A_ssm_k, A_ssm_D, B_x, B_w_gate, B_w_up, B_w_down):
    def _A_ref(q, k, v, shift_k, ssm_k, ssm_D):
        B, S, D = q.shape
        ks = shift_k.shape[-1]
        k_pad = _pad(k, ((0, 0), (ks - 1, 0), (0, 0)))
        k_shift = torch.zeros_like(k)
        for t in range(ks):
            k_shift = k_shift + k_pad[:, t:t + S, :] * shift_k[:, ks - 1 - t][None, None, :]
        kv = k_shift * v
        L = 2 * S
        kv_pad = _pad(kv, ((0, 0), (0, S), (0, 0)))
        kf_pad = _pad(ssm_k, ((0, 0), (0, S)))
        kv_f = (lambda x, axes=(-2,-1): torch.fft.rfft2(x.float(), dim=axes))(kv_pad[:, None, :, :], axes=(1, 2))
        kf_f = (lambda x, axes=(-2,-1): torch.fft.rfft2(x.float(), dim=axes))(kf_pad[:, None, :], axes=(1, 2))
        kf_f = (lambda x, *d: x.permute(*d))(kf_f, 1, 2, 0)
        y_f = kv_f * kf_f[None, :, :, :]
        y = (lambda x, s, axes=(-2,-1): torch.fft.irfft2(x, s=s, dim=axes).to(torch.bfloat16))(y_f, (1, L), axes=(1, 2))[:, 0, :S, :]
        y = y + kv * ssm_D[None, None, :]
        return q * y

    def _B_ref(x, w_gate, w_up, w_down):
        g = torch.einsum("bsd,df->bsf", x, w_gate)
        u = torch.einsum("bsd,df->bsf", x, w_up)
        h = g * u
        return torch.einsum("bsf,fd->bsd", h, w_down)

    x = A_q
    h = x + _A_ref(_layernorm(x, axis=-1), A_k, A_v, A_shift_k, A_ssm_k, A_ssm_D)
    h2 = h + _B_ref(_layernorm(h, axis=-1), B_w_gate, B_w_up, B_w_down)
    return h2
```

```asm
; @launch kernel=gp_kernel grid=(256,1,1) block=(256,1,1) lds=163840
.amdgcn_target "amdgcn-amd-amdhsa--gfx950"
.text
.globl gp_kernel
.p2align 8
.type gp_kernel,@function
gp_kernel:
    s_cmp_ge_u32 s2, 256
    s_cbranch_scc1 gp_kernel_end
    s_load_dwordx2 s[4:5], s[0:1], 96
    v_lshrrev_b32 v2, 6, v0
    v_and_b32 v1, 63, v0
    v_readfirstlane_b32 s3, v2
    s_load_dwordx2 s[16:17], s[0:1], 56
    s_load_dwordx2 s[20:21], s[0:1], 64
    s_lshl_b32 s34, s3, 3
    s_lshr_b32 s35, 0x48001008, s34
    s_and_b32 s35, s35, 0xff
    s_load_dwordx2 s[8:9], s[0:1], s35
    s_cmp_eq_u32 s3, 3
    s_cselect_b32 s35, 32, 24
    s_load_dwordx2 s[12:13], s[0:1], s35
    s_mov_b32 s26, 2621440
    s_cselect_b32 s10, 1966080, s26
    s_cselect_b32 s14, s26, 5120
    s_load_dwordx2 s[24:25], s[0:1], 80
    s_load_dwordx2 s[32:33], s[0:1], 40
    s_mov_b32 s6, 0x1500000
    s_mov_b32 s7, 0x20000
    s_mov_b32 s11, 0x20000
    s_mov_b32 s15, 0x20000
    s_mov_b32 s18, 1966080
    s_mov_b32 s19, 0x20000
    s_mov_b32 s27, 0x20000
    s_and_b32 s44, s2, 7
    s_lshr_b32 s45, s2, 3
    s_lshr_b32 s36, s2, 6
    s_lshl_b32 s36, s36, 3
    s_add_u32 s36, s36, s44
    s_and_b32 s37, s45, 7
    s_cmp_eq_u32 s3, 3
    s_cselect_b32 s38, s45, s36
    s_cselect_b32 s39, s44, s37
    s_mul_i32 s38, s38, 81920
    s_mul_i32 s39, s39, 160
    s_add_u32 s38, s38, s39
    s_mul_i32 s39, s3, 10240
    s_add_u32 s39, s39, 640
    v_mul_u32_u24 v8, 205, v1
    v_lshrrev_b32 v8, 11, v8
    v_mul_u32_u24 v12, 1120, v8
    v_lshl_add_u32 v12, v1, 4, v12
    s_bfe_u32 s46, s44, 0x10001
    s_and_b32 s47, s44, 1
    s_lshl_b32 s47, s47, 2
    s_lshr_b32 s34, s45, 3
    s_add_u32 s47, s47, s34
    s_lshr_b32 s49, s44, 2
    s_lshl_b32 s49, s49, 3
    s_and_b32 s34, s45, 7
    s_add_u32 s49, s49, s34
    s_lshl_b32 s48, s46, 3
    s_add_u32 s48, s48, s47
    s_lshr_b32 s50, s2, 1
    s_mul_i32 s50, s50, 5
    s_and_b32 s34, s2, 1
    s_mul_i32 s34, s34, 3
    s_add_u32 s50, s50, s34
    s_cmp_eq_u32 s3, 3
    s_cbranch_scc1 gp_kernel_A3
    s_waitcnt lgkmcnt(0)
    s_mov_b32 exec_hi, 0x0fffffff
    s_add_u32 m0, s39, 0
    s_add_u32 s40, s38, 0
    buffer_load_dwordx4 v12, s[8:11], s40 offen nt lds
    s_add_u32 m0, s39, 960
    s_add_u32 s40, s38, 7680
    buffer_load_dwordx4 v12, s[8:11], s40 offen nt lds
    s_add_u32 m0, s39, 1920
    s_add_u32 s40, s38, 15360
    buffer_load_dwordx4 v12, s[8:11], s40 offen nt lds
    s_add_u32 m0, s39, 2880
    s_add_u32 s40, s38, 23040
    buffer_load_dwordx4 v12, s[8:11], s40 offen nt lds
    s_add_u32 m0, s39, 3840
    s_add_u32 s40, s38, 30720
    buffer_load_dwordx4 v12, s[8:11], s40 offen nt lds
    s_add_u32 m0, s39, 4800
    s_add_u32 s40, s38, 38400
    buffer_load_dwordx4 v12, s[8:11], s40 offen nt lds
    s_add_u32 m0, s39, 5760
    s_add_u32 s40, s38, 46080
    buffer_load_dwordx4 v12, s[8:11], s40 offen nt lds
    s_add_u32 m0, s39, 6720
    s_add_u32 s40, s38, 53760
    buffer_load_dwordx4 v12, s[8:11], s40 offen nt lds
    s_add_u32 m0, s39, 7680
    s_add_u32 s40, s38, 61440
    buffer_load_dwordx4 v12, s[8:11], s40 offen nt lds
    s_add_u32 m0, s39, 8640
    s_add_u32 s40, s38, 69120
    buffer_load_dwordx4 v12, s[8:11], s40 offen nt lds
    s_mov_b32 exec_hi, 0xff
    s_add_u32 m0, s39, 9600
    s_add_u32 s40, s38, 76800
    buffer_load_dwordx4 v12, s[8:11], s40 offen nt lds
    s_mov_b32 exec_hi, -1
    s_mov_b32 s34, 0x79c000
    s_load_dword s28, s[4:5], s34
    s_add_u32 s34, s50, s3
    s_min_u32 s34, s34, 639
    s_lshl_b32 s51, s34, 1
    s_and_b32 s34, s51, 0xfffffffc
    s_load_dword s30, s[32:33], s34
    v_lshrrev_b32 v248, 4, v1
    v_bfe_u32 v249, v1, 2, 2
    v_and_b32 v250, 3, v1
    s_add_u32 s95, s45, s47
    s_and_b32 s95, s95, 3
    s_lshr_b32 s34, s47, 1
    s_sub_u32 s34, s34, s95
    s_and_b32 s34, s34, 3
    s_cmp_eq_u32 s34, 0
    s_cselect_b32 s93, 20480, 0
    s_cselect_b32 s97, 81920, 81920
    s_mul_i32 s34, s34, 20480
    s_and_b32 s35, s47, 1
    s_mul_i32 s35, s35, 10240
    s_add_u32 s34, s34, s35
    s_and_b32 s59, s3, 1
    s_lshl_b32 s35, s59, 10
    s_add_u32 s34, s34, s35
    s_add_u32 s34, s34, 81920
    s_sub_u32 s22, s34, s97
    s_lshr_b32 s35, s3, 1
    s_lshl_b32 s23, s46, 1
    s_add_u32 s23, s23, s35
    s_lshl_b32 s92, s49, 2
    s_add_u32 s92, s92, s23
    s_mul_i32 s92, s92, 20480
    s_mul_i32 s34, s47, 160
    s_add_u32 s92, s92, s34
    s_lshl_b32 s59, s59, 4
    s_add_u32 s92, s92, s59
    s_lshl_b32 s90, s3, 7
    s_add_u32 s90, s90, s93
    s_add_u32 s90, s90, 0
    s_sub_u32 s93, 40960, s93
    s_mul_i32 s94, s49, 196608
    s_add_u32 s94, s94, 0xe00000
    s_mul_i32 s34, s46, 98304
    s_add_u32 s89, s94, s34
    s_mul_i32 s34, s3, 12288
    s_add_u32 s89, s89, s34
    s_lshl_b32 s34, s48, 2
    s_add_u32 s34, s34, s3
    s_mul_i32 s35, s34, 768
    s_add_u32 s94, s94, s35
    s_lshl_b32 s35, s49, 12
    s_add_u32 s35, s35, 0x7a0000
    s_lshl_b32 s34, s34, 6
    s_add_u32 s85, s35, s34
    s_lshl_b32 s34, s3, 10
    s_add_u32 s86, s35, s34
    s_lshl_b32 s34, s3, 12
    s_add_u32 s87, s34, 0x798000
    s_mul_i32 s88, s47, 245760
    s_mul_i32 s34, s3, 61440
    s_add_u32 s88, s88, s34
    s_add_u32 s88, s88, 0xc00000
    s_mov_b32 s29, 0xffff0000
    s_mov_b32 s83, 0
    s_mul_i32 s91, s3, 5120
    s_cmp_lg_u32 s3, 0
    s_cbranch_scc1 gp_kernel_A_nopre
    s_mov_b32 exec_hi, 0xff
    s_cmp_eq_u32 s36, 0
    s_cbranch_scc1 gp_kernel_A_zpre
    s_mov_b32 m0, 0
    s_sub_u32 s40, s38, 5120
    buffer_load_dwordx4 v12, s[8:11], s40 offen nt lds
    s_branch gp_kernel_A_pre
gp_kernel_A_zpre:
    v_mov_b32 v16, 0
    v_mov_b32 v17, 0
    v_mov_b32 v18, 0
    v_mov_b32 v19, 0
    v_lshlrev_b32 v20, 4, v1
    ds_write_b128 v20, v[16:19]
gp_kernel_A_pre:
    s_mov_b32 exec_hi, -1
gp_kernel_A_nopre:
    v_and_b32 v15, 15, v1
    v_lshlrev_b32 v14, 3, v15
    s_mul_i32 s34, s37, 80
    s_lshl_b32 s35, s3, 5
    s_add_u32 s34, s34, s35
    s_lshl_b32 s35, s34, 3
    buffer_load_dwordx2 v[144:145], v14, s[12:15], s35 offen
    buffer_load_dwordx2 v[146:147], v14, s[12:15], s35 offen offset:128
    s_lshl_b32 s52, s34, 12
    s_lshl_b32 s35, s36, 7
    s_add_u32 s52, s52, s35
    s_add_u32 s53, s52, 0x280000
    s_add_u32 s54, s52, 65536
    s_add_u32 s55, s53, 65536
    s_cmp_lg_u32 s3, 2
    s_cbranch_scc1 gp_kernel_A_nost
    v_lshrrev_b32 v14, 3, v1
    v_mul_u32_u24 v14, 1152, v14
    v_lshl_add_u32 v14, v1, 4, v14
    s_lshl_b32 s34, s36, 3
    s_add_u32 s34, s34, s37
    s_mul_i32 s35, s34, 10240
    buffer_load_dwordx4 v[16:19], v14, s[8:11], s35 offen offset:0 nt
    buffer_load_dwordx4 v[20:23], v14, s[8:11], s35 offen offset:128 nt
    buffer_load_dwordx4 v[24:27], v14, s[8:11], s35 offen offset:256 nt
    buffer_load_dwordx4 v[28:31], v14, s[8:11], s35 offen offset:384 nt
    buffer_load_dwordx4 v[32:35], v14, s[8:11], s35 offen offset:512 nt
    buffer_load_dwordx4 v[36:39], v14, s[8:11], s35 offen offset:640 nt
    buffer_load_dwordx4 v[40:43], v14, s[8:11], s35 offen offset:768 nt
    buffer_load_dwordx4 v[44:47], v14, s[8:11], s35 offen offset:896 nt
    buffer_load_dwordx4 v[48:51], v14, s[8:11], s35 offen offset:1024 nt
    buffer_load_dwordx4 v[52:55], v14, s[8:11], s35 offen offset:1152 nt
    s_lshl_b32 s56, s34, 5
    s_add_u32 s56, s56, 0x780000
    s_add_u32 s57, s56, 8192
gp_kernel_A_nost:
    v_lshlrev_b32 v15, 12, v15
    v_lshl_add_u32 v15, v248, 4, v15
    v_lshl_add_u32 v14, v248, 4, v249
    v_mul_u32_u24 v14, 160, v14
    v_lshl_add_u32 v14, v250, 3, v14
    s_lshl_b32 s34, s3, 6
    v_add_u32 v14, s34, v14
    v_sub_u32 v13, v250, v249
    v_lshlrev_b32 v13, 3, v13
    v_lshlrev_b32 v251, 6, v248
    v_sub_u32 v13, v13, v251
    v_add_u32 v13, 82144, v13
    s_lshl_b32 s34, s37, 5
    s_add_u32 s34, s34, s36
    s_lshl_b32 s34, s34, 6
    s_add_u32 s58, s34, 0x790000
    s_cmp_eq_u32 s3, 0
    s_cselect_b32 s58, s58, s6
    v_lshrrev_b32 v61, 3, v1
    v_mul_u32_u24 v61, 1024, v61
    v_lshl_add_u32 v61, v1, 4, v61
    v_mov_b32 v56, 0
    v_mov_b32 v57, 0
    v_mov_b32 v58, 0
    v_mov_b32 v59, 0
    v_min_u32 v62, 5, v1
    v_lshrrev_b32 v60, 1, v62
    v_mul_u32_u24 v60, 4096, v60
    v_lshl_add_u32 v60, v62, 4, v60
    v_add_u32 v60, 81920, v60
    ds_write_b128 v61, v[56:59] offset:49920
    ds_write_b128 v61, v[56:59] offset:54528
    ds_write_b128 v60, v[56:59]
    s_cmp_eq_u32 s3, 2
    s_cbranch_scc1 gp_kernel_A_w2
    s_waitcnt vmcnt(0)
gp_kernel_A_w2:
    s_waitcnt vmcnt(10) lgkmcnt(0)
    s_barrier
    s_mul_i32 s28, s28, 1664525
    s_add_u32 s28, s28, 1013904223
    s_bitcmp1_b32 s51, 1
    s_cselect_b32 s34, 0, 16
    s_lshl_b32 s30, s30, s34
    s_and_b32 s30, s30, 0xffff0000
    s_mov_b32 s31, s30
    ds_read_b64_tr_b16 v[160:161], v14 offset:0
    ds_read_b64_tr_b16 v[162:163], v14 offset:640
    ds_read_b64_tr_b16 v[164:165], v14 offset:1280
    ds_read_b64_tr_b16 v[166:167], v14 offset:1920
    ds_read_b64_tr_b16 v[168:169], v14 offset:2560
    ds_read_b64_tr_b16 v[180:181], v14 offset:21120
    ds_read_b64_tr_b16 v[182:183], v14 offset:21760
    ds_read_b64_tr_b16 v[184:185], v14 offset:22400
    ds_read_b64_tr_b16 v[186:187], v14 offset:23040
    ds_read_b64_tr_b16 v[170:171], v14 offset:10880
    ds_read_b64_tr_b16 v[172:173], v14 offset:11520
    ds_read_b64_tr_b16 v[174:175], v14 offset:12160
    ds_read_b64_tr_b16 v[176:177], v14 offset:12800
    s_mov_b32 s34, 0x07060100
    v_alignbit_b32 v148, v144, v144, 16
    v_alignbit_b32 v149, v145, v145, 16
    v_and_b32 v150, 0xffff, v144
    v_perm_b32 v151, v144, v145, s34
    v_and_b32 v152, 0xffff0000, v145
    v_alignbit_b32 v153, v146, v146, 16
    v_alignbit_b32 v154, v147, v147, 16
    v_and_b32 v155, 0xffff, v146
    v_perm_b32 v156, v146, v147, s34
    v_and_b32 v157, 0xffff0000, v147
    ds_read_b64_tr_b16 v[204:205], v14 offset:32
    ds_read_b64_tr_b16 v[206:207], v14 offset:672
    ds_read_b64_tr_b16 v[208:209], v14 offset:1312
    ds_read_b64_tr_b16 v[210:211], v14 offset:1952
    ds_read_b64_tr_b16 v[212:213], v14 offset:2592
    ds_read_b64_tr_b16 v[224:225], v14 offset:21152
    ds_read_b64_tr_b16 v[226:227], v14 offset:21792
    ds_read_b64_tr_b16 v[228:229], v14 offset:22432
    ds_read_b64_tr_b16 v[230:231], v14 offset:23072
    ds_read_b64_tr_b16 v[214:215], v14 offset:10912
    ds_read_b64_tr_b16 v[216:217], v14 offset:11552
    ds_read_b64_tr_b16 v[218:219], v14 offset:12192
    ds_read_b64_tr_b16 v[220:221], v14 offset:12832
    s_waitcnt lgkmcnt(15)
    v_dot2_f32_bf16 v188, v160, v152, 0
    v_dot2_f32_bf16 v189, v161, v149, 0
    v_dot2_f32_bf16 v190, v161, v152, 0
    v_dot2_f32_bf16 v191, v162, v149, 0
    v_dot2_f32_bf16 v192, v162, v152, 0
    v_dot2_f32_bf16 v193, v163, v149, 0
    v_dot2_f32_bf16 v194, v163, v152, 0
    v_dot2_f32_bf16 v195, v164, v149, 0
    v_dot2_f32_bf16 v196, v164, v152, 0
    v_dot2_f32_bf16 v197, v165, v149, 0
    v_dot2_f32_bf16 v198, v165, v152, 0
    v_dot2_f32_bf16 v199, v166, v149, 0
    v_dot2_f32_bf16 v200, v166, v152, 0
    v_dot2_f32_bf16 v201, v167, v149, 0
    v_dot2_f32_bf16 v202, v167, v152, 0
    v_dot2_f32_bf16 v203, v168, v149, 0
    buffer_store_dwordx4 v[180:183], v15, s[4:7], s53 offen sc1
    buffer_store_dwordx4 v[184:187], v15, s[4:7], s53 offen offset:64 sc1
    v_dot2_f32_bf16 v188, v161, v151, v188
    v_dot2_f32_bf16 v189, v162, v148, v189
    v_dot2_f32_bf16 v190, v162, v151, v190
    v_dot2_f32_bf16 v191, v163, v148, v191
    v_dot2_f32_bf16 v192, v163, v151, v192
    v_dot2_f32_bf16 v193, v164, v148, v193
    v_dot2_f32_bf16 v194, v164, v151, v194
    v_dot2_f32_bf16 v195, v165, v148, v195
    v_dot2_f32_bf16 v196, v165, v151, v196
    v_dot2_f32_bf16 v197, v166, v148, v197
    v_dot2_f32_bf16 v198, v166, v151, v198
    v_dot2_f32_bf16 v199, v167, v148, v199
    v_dot2_f32_bf16 v200, v167, v151, v200
    v_dot2_f32_bf16 v201, v168, v148, v201
    v_dot2_f32_bf16 v202, v168, v151, v202
    v_dot2_f32_bf16 v203, v169, v148, v203
    v_dot2_f32_bf16 v188, v162, v150, v188
    v_dot2_f32_bf16 v190, v163, v150, v190
    v_dot2_f32_bf16 v192, v164, v150, v192
    v_dot2_f32_bf16 v194, v165, v150, v194
    v_dot2_f32_bf16 v196, v166, v150, v196
    v_dot2_f32_bf16 v198, v167, v150, v198
    v_dot2_f32_bf16 v200, v168, v150, v200
    v_dot2_f32_bf16 v202, v169, v150, v202
    s_waitcnt lgkmcnt(13)
    v_lshlrev_b32 v250, 16, v170
    v_and_b32 v251, 0xffff0000, v170
    v_pk_mul_f32 v[188:189], v[188:189], v[250:251]
    v_lshlrev_b32 v252, 16, v171
    v_and_b32 v253, 0xffff0000, v171
    v_pk_mul_f32 v[190:191], v[190:191], v[252:253]
    v_lshlrev_b32 v250, 16, v172
    v_and_b32 v251, 0xffff0000, v172
    v_pk_mul_f32 v[192:193], v[192:193], v[250:251]
    v_lshlrev_b32 v252, 16, v173
    v_and_b32 v253, 0xffff0000, v173
    v_pk_mul_f32 v[194:195], v[194:195], v[252:253]
    v_lshlrev_b32 v250, 16, v174
    v_and_b32 v251, 0xffff0000, v174
    v_pk_mul_f32 v[196:197], v[196:197], v[250:251]
    v_lshlrev_b32 v252, 16, v175
    v_and_b32 v253, 0xffff0000, v175
    v_pk_mul_f32 v[198:199], v[198:199], v[252:253]
    v_lshlrev_b32 v250, 16, v176
    v_and_b32 v251, 0xffff0000, v176
    v_pk_mul_f32 v[200:201], v[200:201], v[250:251]
    v_lshlrev_b32 v252, 16, v177
    v_and_b32 v253, 0xffff0000, v177
    v_pk_mul_f32 v[202:203], v[202:203], v[252:253]
    v_cvt_pk_bf16_f32 v160, v188, v192
    v_cvt_pk_bf16_f32 v161, v196, v200
    v_cvt_pk_bf16_f32 v162, v189, v193
    v_cvt_pk_bf16_f32 v163, v197, v201
    v_cvt_pk_bf16_f32 v164, v190, v194
    v_cvt_pk_bf16_f32 v165, v198, v202
    v_cvt_pk_bf16_f32 v166, v191, v195
    v_cvt_pk_bf16_f32 v167, v199, v203
    s_nop 0
    v_permlane16_swap_b32 v160, v162
    v_permlane16_swap_b32 v161, v163
    v_permlane16_swap_b32 v164, v166
    v_permlane16_swap_b32 v165, v167
    buffer_store_dwordx4 v[160:163], v15, s[4:7], s52 offen sc1
    buffer_store_dwordx4 v[164:167], v15, s[4:7], s52 offen offset:64 sc1
    s_cmp_eq_u32 s3, 2
    s_cbranch_scc1 gp_kernel_A_stat
    s_waitcnt lgkmcnt(8)
    v_dot2_f32_bf16 v232, v204, v157, 0
    v_dot2_f32_bf16 v233, v205, v154, 0
    v_dot2_f32_bf16 v234, v205, v157, 0
    v_dot2_f32_bf16 v235, v206, v154, 0
    v_dot2_f32_bf16 v236, v206, v157, 0
    v_dot2_f32_bf16 v237, v207, v154, 0
    v_dot2_f32_bf16 v238, v207, v157, 0
    v_dot2_f32_bf16 v239, v208, v154, 0
    v_dot2_f32_bf16 v240, v208, v157, 0
    v_dot2_f32_bf16 v241, v209, v154, 0
    v_dot2_f32_bf16 v242, v209, v157, 0
    v_dot2_f32_bf16 v243, v210, v154, 0
    v_dot2_f32_bf16 v244, v210, v157, 0
    v_dot2_f32_bf16 v245, v211, v154, 0
    v_dot2_f32_bf16 v246, v211, v157, 0
    v_dot2_f32_bf16 v247, v212, v154, 0
    s_waitcnt lgkmcnt(4)
    buffer_store_dwordx4 v[224:227], v15, s[4:7], s55 offen sc1
    buffer_store_dwordx4 v[228:231], v15, s[4:7], s55 offen offset:64 sc1
    v_dot2_f32_bf16 v232, v205, v156, v232
    v_dot2_f32_bf16 v233, v206, v153, v233
    v_dot2_f32_bf16 v234, v206, v156, v234
    v_dot2_f32_bf16 v235, v207, v153, v235
    v_dot2_f32_bf16 v236, v207, v156, v236
    v_dot2_f32_bf16 v237, v208, v153, v237
    v_dot2_f32_bf16 v238, v208, v156, v238
    v_dot2_f32_bf16 v239, v209, v153, v239
    v_dot2_f32_bf16 v240, v209, v156, v240
    v_dot2_f32_bf16 v241, v210, v153, v241
    v_dot2_f32_bf16 v242, v210, v156, v242
    v_dot2_f32_bf16 v243, v211, v153, v243
    v_dot2_f32_bf16 v244, v211, v156, v244
    v_dot2_f32_bf16 v245, v212, v153, v245
    v_dot2_f32_bf16 v246, v212, v156, v246
    v_dot2_f32_bf16 v247, v213, v153, v247
    v_dot2_f32_bf16 v232, v206, v155, v232
    v_dot2_f32_bf16 v234, v207, v155, v234
    v_dot2_f32_bf16 v236, v208, v155, v236
    v_dot2_f32_bf16 v238, v209, v155, v238
    v_dot2_f32_bf16 v240, v210, v155, v240
    v_dot2_f32_bf16 v242, v211, v155, v242
    v_dot2_f32_bf16 v244, v212, v155, v244
    v_dot2_f32_bf16 v246, v213, v155, v246
    s_waitcnt lgkmcnt(0)
    v_lshlrev_b32 v250, 16, v214
    v_and_b32 v251, 0xffff0000, v214
    v_pk_mul_f32 v[232:233], v[232:233], v[250:251]
    v_lshlrev_b32 v252, 16, v215
    v_and_b32 v253, 0xffff0000, v215
    v_pk_mul_f32 v[234:235], v[234:235], v[252:253]
    v_lshlrev_b32 v250, 16, v216
    v_and_b32 v251, 0xffff0000, v216
    v_pk_mul_f32 v[236:237], v[236:237], v[250:251]
    v_lshlrev_b32 v252, 16, v217
    v_and_b32 v253, 0xffff0000, v217
    v_pk_mul_f32 v[238:239], v[238:239], v[252:253]
    v_lshlrev_b32 v250, 16, v218
    v_and_b32 v251, 0xffff0000, v218
    v_pk_mul_f32 v[240:241], v[240:241], v[250:251]
    v_lshlrev_b32 v252, 16, v219
    v_and_b32 v253, 0xffff0000, v219
    v_pk_mul_f32 v[242:243], v[242:243], v[252:253]
    v_lshlrev_b32 v250, 16, v220
    v_and_b32 v251, 0xffff0000, v220
    v_pk_mul_f32 v[244:245], v[244:245], v[250:251]
    v_lshlrev_b32 v252, 16, v221
    v_and_b32 v253, 0xffff0000, v221
    v_pk_mul_f32 v[246:247], v[246:247], v[252:253]
    v_cvt_pk_bf16_f32 v204, v232, v236
    v_cvt_pk_bf16_f32 v205, v240, v244
    v_cvt_pk_bf16_f32 v206, v233, v237
    v_cvt_pk_bf16_f32 v207, v241, v245
    v_cvt_pk_bf16_f32 v208, v234, v238
    v_cvt_pk_bf16_f32 v209, v242, v246
    v_cvt_pk_bf16_f32 v210, v235, v239
    v_cvt_pk_bf16_f32 v211, v243, v247
    s_nop 0
    v_permlane16_swap_b32 v204, v206
    v_permlane16_swap_b32 v205, v207
    v_permlane16_swap_b32 v208, v210
    v_permlane16_swap_b32 v209, v211
    buffer_store_dwordx4 v[204:207], v15, s[4:7], s54 offen sc1
    buffer_store_dwordx4 v[208:211], v15, s[4:7], s54 offen offset:64 sc1
    s_branch gp_kernel_A_kf
gp_kernel_A_stat:
    s_mov_b32 s34, 0x3f803f80
    s_waitcnt vmcnt(4)
    v_dot2_f32_bf16 v56, v16, s34, 0
    v_dot2_f32_bf16 v60, v16, v16, 0
    v_dot2_f32_bf16 v57, v17, s34, 0
    v_dot2_f32_bf16 v61, v17, v17, 0
    v_dot2_f32_bf16 v58, v18, s34, 0
    v_dot2_f32_bf16 v62, v18, v18, 0
    v_dot2_f32_bf16 v59, v19, s34, 0
    v_dot2_f32_bf16 v63, v19, v19, 0
    v_dot2_f32_bf16 v56, v20, s34, v56
    v_dot2_f32_bf16 v60, v20, v20, v60
    v_dot2_f32_bf16 v57, v21, s34, v57
    v_dot2_f32_bf16 v61, v21, v21, v61
    v_dot2_f32_bf16 v58, v22, s34, v58
    v_dot2_f32_bf16 v62, v22, v22, v62
    v_dot2_f32_bf16 v59, v23, s34, v59
    v_dot2_f32_bf16 v63, v23, v23, v63
    v_dot2_f32_bf16 v56, v24, s34, v56
    v_dot2_f32_bf16 v60, v24, v24, v60
    v_dot2_f32_bf16 v57, v25, s34, v57
    v_dot2_f32_bf16 v61, v25, v25, v61
    v_dot2_f32_bf16 v58, v26, s34, v58
    v_dot2_f32_bf16 v62, v26, v26, v62
    v_dot2_f32_bf16 v59, v27, s34, v59
    v_dot2_f32_bf16 v63, v27, v27, v63
    v_dot2_f32_bf16 v56, v28, s34, v56
    v_dot2_f32_bf16 v60, v28, v28, v60
    v_dot2_f32_bf16 v57, v29, s34, v57
    v_dot2_f32_bf16 v61, v29, v29, v61
    v_dot2_f32_bf16 v58, v30, s34, v58
    v_dot2_f32_bf16 v62, v30, v30, v62
    v_dot2_f32_bf16 v59, v31, s34, v59
    v_dot2_f32_bf16 v63, v31, v31, v63
    v_dot2_f32_bf16 v56, v32, s34, v56
    v_dot2_f32_bf16 v60, v32, v32, v60
    v_dot2_f32_bf16 v57, v33, s34, v57
    v_dot2_f32_bf16 v61, v33, v33, v61
    v_dot2_f32_bf16 v58, v34, s34, v58
    v_dot2_f32_bf16 v62, v34, v34, v62
    v_dot2_f32_bf16 v59, v35, s34, v59
    v_dot2_f32_bf16 v63, v35, v35, v63
    v_dot2_f32_bf16 v56, v36, s34, v56
    v_dot2_f32_bf16 v60, v36, v36, v60
    v_dot2_f32_bf16 v57, v37, s34, v57
    v_dot2_f32_bf16 v61, v37, v37, v61
    v_dot2_f32_bf16 v58, v38, s34, v58
    v_dot2_f32_bf16 v62, v38, v38, v62
    v_dot2_f32_bf16 v59, v39, s34, v59
    v_dot2_f32_bf16 v63, v39, v39, v63
    v_dot2_f32_bf16 v56, v40, s34, v56
    v_dot2_f32_bf16 v60, v40, v40, v60
    v_dot2_f32_bf16 v57, v41, s34, v57
    v_dot2_f32_bf16 v61, v41, v41, v61
    v_dot2_f32_bf16 v58, v42, s34, v58
    v_dot2_f32_bf16 v62, v42, v42, v62
    v_dot2_f32_bf16 v59, v43, s34, v59
    v_dot2_f32_bf16 v63, v43, v43, v63
    v_dot2_f32_bf16 v56, v44, s34, v56
    v_dot2_f32_bf16 v60, v44, v44, v60
    v_dot2_f32_bf16 v57, v45, s34, v57
    v_dot2_f32_bf16 v61, v45, v45, v61
    v_dot2_f32_bf16 v58, v46, s34, v58
    v_dot2_f32_bf16 v62, v46, v46, v62
    v_dot2_f32_bf16 v59, v47, s34, v59
    v_dot2_f32_bf16 v63, v47, v47, v63
    v_dot2_f32_bf16 v56, v48, s34, v56
    v_dot2_f32_bf16 v60, v48, v48, v60
    v_dot2_f32_bf16 v57, v49, s34, v57
    v_dot2_f32_bf16 v61, v49, v49, v61
    v_dot2_f32_bf16 v58, v50, s34, v58
    v_dot2_f32_bf16 v62, v50, v50, v62
    v_dot2_f32_bf16 v59, v51, s34, v59
    v_dot2_f32_bf16 v63, v51, v51, v63
    v_dot2_f32_bf16 v56, v52, s34, v56
    v_dot2_f32_bf16 v60, v52, v52, v60
    v_dot2_f32_bf16 v57, v53, s34, v57
    v_dot2_f32_bf16 v61, v53, v53, v61
    v_dot2_f32_bf16 v58, v54, s34, v58
    v_dot2_f32_bf16 v62, v54, v54, v62
    v_dot2_f32_bf16 v59, v55, s34, v59
    v_dot2_f32_bf16 v63, v55, v55, v63
    v_lshrrev_b32 v64, 1, v1
    v_and_b32 v64, 28, v64
    s_nop 0
    v_pk_add_f32 v[56:57], v[56:57], v[58:59]
    v_pk_add_f32 v[60:61], v[60:61], v[62:63]
    v_add_f32 v56, v56, v57
    v_add_f32 v60, v60, v61
    s_nop 0
    v_add_f32_dpp v56, v56, v56 quad_perm:[1,0,3,2] row_mask:0xf bank_mask:0xf
    v_add_f32_dpp v60, v60, v60 quad_perm:[1,0,3,2] row_mask:0xf bank_mask:0xf
    s_nop 0
    v_add_f32_dpp v56, v56, v56 quad_perm:[2,3,0,1] row_mask:0xf bank_mask:0xf
    v_add_f32_dpp v60, v60, v60 quad_perm:[2,3,0,1] row_mask:0xf bank_mask:0xf
    s_nop 0
    v_add_f32_dpp v56, v56, v56 row_half_mirror row_mask:0xf bank_mask:0xf
    v_add_f32_dpp v60, v60, v60 row_half_mirror row_mask:0xf bank_mask:0xf
    v_mul_f32 v56, 0.0015625, v56
    v_mul_f32 v60, 0.0015625, v60
    v_fma_f32 v60, -v56, v56, v60
    v_max_f32 v60, 0, v60
    v_add_f32 v60, 1e-05, v60
    v_rsq_f32 v60, v60
    s_mov_b32 exec_lo, 0x01010101
    s_mov_b32 exec_hi, 0x01010101
    v_mul_f32_e64 v56, -v56, v60
    buffer_store_dword v60, v64, s[4:7], s56 offen sc1
    buffer_store_dword v56, v64, s[4:7], s57 offen sc1
    s_mov_b64 exec, -1
gp_kernel_A_kf:
    ds_read_b64_tr_b16 v[16:17], v13 offset:32
    ds_read_b64_tr_b16 v[18:19], v13 offset:0
    ds_read_b64_tr_b16 v[20:21], v13 offset:288
    ds_read_b64_tr_b16 v[22:23], v13 offset:256
    ds_read_b64_tr_b16 v[24:25], v13 offset:544
    ds_read_b64_tr_b16 v[26:27], v13 offset:512
    ds_read_b64_tr_b16 v[28:29], v13 offset:800
    ds_read_b64_tr_b16 v[30:31], v13 offset:768
    ds_read_b64_tr_b16 v[32:33], v13 offset:1056
    ds_read_b64_tr_b16 v[34:35], v13 offset:1024
    ds_read_b64_tr_b16 v[36:37], v13 offset:1312
    ds_read_b64_tr_b16 v[38:39], v13 offset:1280
    ds_read_b64_tr_b16 v[40:41], v13 offset:1568
    ds_read_b64_tr_b16 v[42:43], v13 offset:1536
    ds_read_b64_tr_b16 v[44:45], v13 offset:1824
    ds_read_b64_tr_b16 v[46:47], v13 offset:1792
    ds_read_b64_tr_b16 v[48:49], v13 offset:2080
    ds_read_b64_tr_b16 v[50:51], v13 offset:2048
    ds_read_b64_tr_b16 v[52:53], v13 offset:2336
    ds_read_b64_tr_b16 v[54:55], v13 offset:2304
    ds_read_b64_tr_b16 v[56:57], v13 offset:2592
    ds_read_b64_tr_b16 v[58:59], v13 offset:2560
    ds_read_b64_tr_b16 v[60:61], v13 offset:2848
    ds_read_b64_tr_b16 v[62:63], v13 offset:2816
    ds_read_b64_tr_b16 v[64:65], v13 offset:3104
    ds_read_b64_tr_b16 v[66:67], v13 offset:3072
    ds_read_b64_tr_b16 v[68:69], v13 offset:3360
    ds_read_b64_tr_b16 v[70:71], v13 offset:3328
    ds_read_b64_tr_b16 v[72:73], v13 offset:3616
    ds_read_b64_tr_b16 v[74:75], v13 offset:3584
    ds_read_b64_tr_b16 v[76:77], v13 offset:3872
    ds_read_b64_tr_b16 v[78:79], v13 offset:3840
    ds_read_b64_tr_b16 v[80:81], v13 offset:4160
    ds_read_b64_tr_b16 v[82:83], v13 offset:4128
    ds_read_b64_tr_b16 v[84:85], v13 offset:4416
    ds_read_b64_tr_b16 v[86:87], v13 offset:4384
    ds_read_b64_tr_b16 v[88:89], v13 offset:4672
    ds_read_b64_tr_b16 v[90:91], v13 offset:4640
    ds_read_b64_tr_b16 v[92:93], v13 offset:4928
    ds_read_b64_tr_b16 v[94:95], v13 offset:4896
    ds_read_b64_tr_b16 v[96:97], v13 offset:5184
    ds_read_b64_tr_b16 v[98:99], v13 offset:5152
    ds_read_b64_tr_b16 v[100:101], v13 offset:5440
    ds_read_b64_tr_b16 v[102:103], v13 offset:5408
    ds_read_b64_tr_b16 v[104:105], v13 offset:5696
    ds_read_b64_tr_b16 v[106:107], v13 offset:5664
    ds_read_b64_tr_b16 v[108:109], v13 offset:5952
    ds_read_b64_tr_b16 v[110:111], v13 offset:5920
    ds_read_b64_tr_b16 v[112:113], v13 offset:6208
    ds_read_b64_tr_b16 v[114:115], v13 offset:6176
    ds_read_b64_tr_b16 v[116:117], v13 offset:6464
    ds_read_b64_tr_b16 v[118:119], v13 offset:6432
    ds_read_b64_tr_b16 v[120:121], v13 offset:6720
    ds_read_b64_tr_b16 v[122:123], v13 offset:6688
    ds_read_b64_tr_b16 v[124:125], v13 offset:6976
    ds_read_b64_tr_b16 v[126:127], v13 offset:6944
    ds_read_b64_tr_b16 v[128:129], v13 offset:7232
    ds_read_b64_tr_b16 v[130:131], v13 offset:7200
    ds_read_b64_tr_b16 v[132:133], v13 offset:7488
    ds_read_b64_tr_b16 v[134:135], v13 offset:7456
    ds_read_b64_tr_b16 v[136:137], v13 offset:7744
    ds_read_b64_tr_b16 v[138:139], v13 offset:7712
    ds_read_b64_tr_b16 v[140:141], v13 offset:8000
    ds_read_b64_tr_b16 v[142:143], v13 offset:7968
    ds_read_b64_tr_b16 a[180:181], v13 offset:8288
    ds_read_b64_tr_b16 a[182:183], v13 offset:8256
    ds_read_b64_tr_b16 a[184:185], v13 offset:8544
    ds_read_b64_tr_b16 a[186:187], v13 offset:8512
    ds_read_b64_tr_b16 a[188:189], v13 offset:8800
    ds_read_b64_tr_b16 a[190:191], v13 offset:8768
    ds_read_b64_tr_b16 a[192:193], v13 offset:9056
    ds_read_b64_tr_b16 a[194:195], v13 offset:9024
    ds_read_b64_tr_b16 a[196:197], v13 offset:9312
    ds_read_b64_tr_b16 a[198:199], v13 offset:9280
    ds_read_b64_tr_b16 a[200:201], v13 offset:9568
    ds_read_b64_tr_b16 a[202:203], v13 offset:9536
    ds_read_b64_tr_b16 a[204:205], v13 offset:9824
    ds_read_b64_tr_b16 a[206:207], v13 offset:9792
    ds_read_b64_tr_b16 a[208:209], v13 offset:10080
    ds_read_b64_tr_b16 a[210:211], v13 offset:10048
    ds_read_b64_tr_b16 a[212:213], v13 offset:10336
    ds_read_b64_tr_b16 a[214:215], v13 offset:10304
    ds_read_b64_tr_b16 a[216:217], v13 offset:10592
    ds_read_b64_tr_b16 a[218:219], v13 offset:10560
    ds_read_b64_tr_b16 a[220:221], v13 offset:10848
    ds_read_b64_tr_b16 a[222:223], v13 offset:10816
    ds_read_b64_tr_b16 a[224:225], v13 offset:11104
    ds_read_b64_tr_b16 a[226:227], v13 offset:11072
    ds_read_b64_tr_b16 a[228:229], v13 offset:11360
    ds_read_b64_tr_b16 a[230:231], v13 offset:11328
    ds_read_b64_tr_b16 a[232:233], v13 offset:11616
    ds_read_b64_tr_b16 a[234:235], v13 offset:11584
    ds_read_b64_tr_b16 a[236:237], v13 offset:11872
    ds_read_b64_tr_b16 a[238:239], v13 offset:11840
    ds_read_b64_tr_b16 a[240:241], v13 offset:12128
    ds_read_b64_tr_b16 a[242:243], v13 offset:12096
    v_mov_b32 v0, s28
    v_mov_b32 v244, 0
    s_mov_b32 s84, 0
    v_lshrrev_b32 v248, 4, v1
    v_bfe_u32 v249, v1, 2, 2
    v_and_b32 v250, 3, v1
    v_lshlrev_b32 v2, 4, v1
    v_lshrrev_b32 v3, 1, v1
    v_lshlrev_b32 v3, 7, v3
    v_and_b32 v4, 1, v1
    v_lshrrev_b32 v10, 3, v1
    v_lshlrev_b32 v10, 7, v10
    v_lshl_add_u32 v10, v4, 6, v10
    v_lshl_add_u32 v3, v4, 5, v3
    v_bfe_u32 v4, v1, 1, 2
    v_lshl_add_u32 v10, v4, 4, v10
    v_lshl_add_u32 v4, v250, 2, v249
    v_lshlrev_b32 v4, 3, v4
    v_lshl_add_u32 v4, v248, 4, v4
    s_mul_i32 s41, s3, 3456
    s_add_u32 s34, s41, 49928
    s_add_u32 s41, s41, 50048
    v_add_u32 v4, s34, v4
    v_add_u32 v12, 1152, v4
    v_add_u32 v14, 2304, v4
    s_mul_i32 s34, s3, 4116
    v_lshl_add_u32 v5, v1, 2, s34
    s_mul_i32 s34, s3, 4112
    v_lshl_add_u32 v6, v250, 2, s34
    s_mul_i32 s34, s3, 16640
    v_lshl_add_u32 v7, v1, 5, s34
    s_mul_i32 s34, s3, 1152
    s_add_u32 s34, s34, 50048
    v_lshl_add_u32 v8, v1, 2, s34
    v_lshlrev_b32 v9, 5, v1
    v_add_u32 v9, 63744, v9
    v_lshlrev_b32 v11, 6, v1
    v_mov_b32 v15, 0
    s_and_b32 s34, s3, 1
    s_mul_i32 s34, s34, 49152
    s_mul_i32 s35, s48, 192
    s_add_u32 s34, s34, s35
    s_lshl_b32 s35, s49, 7
    s_add_u32 s35, s35, 0x500000
    s_add_u32 s59, s95, 0
    s_and_b32 s59, s59, 3
    s_mul_i32 s60, s59, 491520
    s_add_u32 s60, s60, s34
    s_mul_i32 s52, s59, 655360
    s_add_u32 s52, s52, s35
    s_add_u32 s59, s95, 1
    s_and_b32 s59, s59, 3
    s_mul_i32 s61, s59, 491520
    s_add_u32 s61, s61, s34
    s_mul_i32 s53, s59, 655360
    s_add_u32 s53, s53, s35
    s_add_u32 s59, s95, 2
    s_and_b32 s59, s59, 3
    s_mul_i32 s62, s59, 491520
    s_add_u32 s62, s62, s34
    s_mul_i32 s54, s59, 655360
    s_add_u32 s54, s54, s35
    s_add_u32 s59, s95, 3
    s_and_b32 s59, s59, 3
    s_mul_i32 s63, s59, 491520
    s_add_u32 s63, s63, s34
    s_mul_i32 s55, s59, 655360
    s_add_u32 s55, s55, s35
    s_lshl_b32 s40, s50, 12
    s_lshl_b32 s34, s3, 12
    s_add_u32 s35, s40, s34
    s_add_u32 s100, s35, 0x280000
    s_add_u32 s56, s35, 0x500000
    s_add_u32 s42, s34, 63744
    s_add_u32 s43, s34, 0x780000
    s_add_u32 s38, s34, 0x790000
    s_lshr_b32 s34, s3, 1
    s_lshl_b32 s34, s34, 6
    s_add_u32 s40, s40, s34
    s_and_b32 s34, s3, 1
    s_lshl_b32 s34, s34, 4
    s_add_u32 s40, s40, s34
    s_and_b32 s34, s2, 1
    s_lshl_b32 s34, s34, 2
    s_add_u32 s34, s34, s3
    s_cmp_eq_u32 s34, 6
    s_cselect_b32 s56, s6, s56
    s_cselect_b32 s100, s6, s100
    s_cmp_eq_u32 s3, 3
    s_cselect_b32 s100, s6, s100
    s_or_b32 s34, s2, s3
    s_cmp_eq_u32 s34, 0
    s_cselect_b32 s101, 0x79c000, s6
    s_lshl_b32 s34, s2, 6
    s_add_u32 s57, s34, 0x794000
    s_add_u32 s39, s34, 0x798000
    s_cmp_eq_u32 s3, 0
    s_cselect_b32 s57, s57, s6
    s_cselect_b32 s39, s39, s6
    v_add_u32 v208, 0, v1
    v_mul_u32_u24 v209, 171, v208
    v_lshrrev_b32 v209, 11, v209
    v_mul_u32_u24 v210, 12, v209
    v_sub_u32 v208, v208, v210
    v_bfe_u32 v210, v209, 2, 1
    v_lshlrev_b32 v210, 1, v210
    v_sub_u32 v208, v208, v210
    v_add_u32 v210, 12, v208
    v_min_u32 v208, v208, v210
    v_mul_u32_u24 v209, 3072, v209
    v_lshl_add_u32 v208, v208, 4, v209
    v_subrev_u32 v13, 0, v208
    v_add_u32 v208, 64, v1
    v_mul_u32_u24 v209, 171, v208
    v_lshrrev_b32 v209, 11, v209
    v_mul_u32_u24 v210, 12, v209
    v_sub_u32 v208, v208, v210
    v_bfe_u32 v210, v209, 2, 1
    v_lshlrev_b32 v210, 1, v210
    v_sub_u32 v208, v208, v210
    v_add_u32 v210, 12, v208
    v_min_u32 v208, v208, v210
    v_mul_u32_u24 v209, 3072, v209
    v_lshl_add_u32 v208, v208, 4, v209
    v_subrev_u32 v254, 1024, v208
    v_add_u32 v208, 128, v1
    v_mul_u32_u24 v209, 171, v208
    v_lshrrev_b32 v209, 11, v209
    v_mul_u32_u24 v210, 12, v209
    v_sub_u32 v208, v208, v210
    v_bfe_u32 v210, v209, 2, 1
    v_lshlrev_b32 v210, 1, v210
    v_sub_u32 v208, v208, v210
    v_add_u32 v210, 12, v208
    v_min_u32 v208, v208, v210
    v_mul_u32_u24 v209, 3072, v209
    v_lshl_add_u32 v208, v208, 4, v209
    v_subrev_u32 v255, 2048, v208
    v_lshl_add_u32 v208, v248, 2, v249
    v_mul_u32_u24 v208, 192, v208
    v_and_b32 v209, 1, v250
    v_lshl_add_u32 v208, v209, 3, v208
    v_and_b32 v209, 1, v248
    s_mul_i32 s34, s3, 3
    v_lshl_add_u32 v209, v209, 1, s34
    v_lshrrev_b32 v210, 1, v250
    v_add_u32 v211, v209, v210
    v_add_u32 v212, -12, v211
    v_min_u32 v211, v211, v212
    v_lshl_add_u32 v213, v211, 4, v208
    v_add_u32 v209, 2, v209
    v_add_u32 v212, -12, v209
    v_min_u32 v209, v209, v212
    v_lshl_add_u32 v214, v209, 4, v208
    v_mul_u32_u24 v210, 6144, v210
    v_add_u32 v214, v214, v210
    v_add_u32 v252, 90112, v213
    v_add_u32 v253, 90112, v214
    v_mov_b32 v204, 0x3f803f80
    v_mov_b32 v205, 0x3f803f80
    v_mov_b32 v206, 0x3f803f80
    v_mov_b32 v207, 0x3f803f80
    s_mul_i32 s80, s3, 3072
    s_cmp_ge_u32 s3, 2
    s_cselect_b32 s16, s20, s16
    s_cselect_b32 s17, s21, s17
    s_mul_i32 s82, s44, 24
    s_add_u32 s82, s82, s45
    s_mul_i32 s81, s82, 10240
    s_add_u32 s81, s81, 0xc00000
    s_lshl_b32 s82, s82, 6
    s_add_u32 s82, s82, 0x7c0000
    s_cmp_lt_u32 s2, 192
    s_cselect_b32 s34, s3, 0
    s_cmp_eq_u32 s34, 3
    s_cselect_b32 s82, s82, s6
    s_waitcnt vmcnt(0)
    s_branch gp_kernel_B2
gp_kernel_A3:
    v_lshlrev_b32 v14, 4, v1
    s_lshl_b32 s40, s50, 12
    s_waitcnt lgkmcnt(0)
    s_mov_b32 m0, 81952
    s_nop 0
    buffer_load_dwordx4 v14, s[12:15], s40 offen offset:0 nt lds
    buffer_load_dwordx4 v14, s[12:15], s40 offen offset:1024 nt lds
    buffer_load_dwordx4 v14, s[12:15], s40 offen offset:2048 nt lds
    buffer_load_dwordx4 v14, s[12:15], s40 offen offset:3072 nt lds
    s_mov_b32 m0, 86080
    s_add_u32 s40, s40, 4096
    buffer_load_dwordx4 v14, s[12:15], s40 offen offset:0 nt lds
    buffer_load_dwordx4 v14, s[12:15], s40 offen offset:1024 nt lds
    buffer_load_dwordx4 v14, s[12:15], s40 offen offset:2048 nt lds
    buffer_load_dwordx4 v14, s[12:15], s40 offen offset:3072 nt lds
    s_mov_b32 m0, 90208
    s_add_u32 s40, s40, 4096
    buffer_load_dwordx4 v14, s[12:15], s40 offen offset:0 nt lds
    buffer_load_dwordx4 v14, s[12:15], s40 offen offset:1024 nt lds
    buffer_load_dwordx4 v14, s[12:15], s40 offen offset:2048 nt lds
    buffer_load_dwordx4 v14, s[12:15], s40 offen offset:3072 nt lds
    s_mov_b32 s34, 0x79c000
    s_load_dword s28, s[4:5], s34
    s_add_u32 s34, s50, s3
    s_min_u32 s34, s34, 639
    s_lshl_b32 s51, s34, 1
    s_and_b32 s34, s51, 0xfffffffc
    s_load_dword s30, s[32:33], s34
    v_lshrrev_b32 v248, 4, v1
    v_bfe_u32 v249, v1, 2, 2
    v_and_b32 v250, 3, v1
    s_add_u32 s95, s45, s47
    s_and_b32 s95, s95, 3
    s_lshr_b32 s34, s47, 1
    s_sub_u32 s34, s34, s95
    s_and_b32 s34, s34, 3
    s_cmp_eq_u32 s34, 0
    s_cselect_b32 s93, 20480, 0
    s_cselect_b32 s97, 81920, 81920
    s_mul_i32 s34, s34, 20480
    s_and_b32 s35, s47, 1
    s_mul_i32 s35, s35, 10240
    s_add_u32 s34, s34, s35
    s_and_b32 s59, s3, 1
    s_lshl_b32 s35, s59, 10
    s_add_u32 s34, s34, s35
    s_add_u32 s34, s34, 81920
    s_sub_u32 s22, s34, s97
    s_lshr_b32 s35, s3, 1
    s_lshl_b32 s23, s46, 1
    s_add_u32 s23, s23, s35
    s_lshl_b32 s92, s49, 2
    s_add_u32 s92, s92, s23
    s_mul_i32 s92, s92, 20480
    s_mul_i32 s34, s47, 160
    s_add_u32 s92, s92, s34
    s_lshl_b32 s59, s59, 4
    s_add_u32 s92, s92, s59
    s_lshl_b32 s90, s3, 7
    s_add_u32 s90, s90, s93
    s_add_u32 s90, s90, 0
    s_sub_u32 s93, 40960, s93
    s_mul_i32 s94, s49, 196608
    s_add_u32 s94, s94, 0xe00000
    s_mul_i32 s34, s46, 98304
    s_add_u32 s89, s94, s34
    s_mul_i32 s34, s3, 12288
    s_add_u32 s89, s89, s34
    s_lshl_b32 s34, s48, 2
    s_add_u32 s34, s34, s3
    s_mul_i32 s35, s34, 768
    s_add_u32 s94, s94, s35
    s_lshl_b32 s35, s49, 12
    s_add_u32 s35, s35, 0x7a0000
    s_lshl_b32 s34, s34, 6
    s_add_u32 s85, s35, s34
    s_lshl_b32 s34, s3, 10
    s_add_u32 s86, s35, s34
    s_lshl_b32 s34, s3, 12
    s_add_u32 s87, s34, 0x798000
    s_mul_i32 s88, s47, 245760
    s_mul_i32 s34, s3, 61440
    s_add_u32 s88, s88, s34
    s_add_u32 s88, s88, 0xc00000
    s_mov_b32 s29, 0xffff0000
    s_mov_b32 s83, 0
    s_mul_i32 s91, s3, 5120
    v_sub_u32 v13, v250, v249
    v_lshlrev_b32 v13, 3, v13
    v_lshlrev_b32 v251, 6, v248
    v_sub_u32 v13, v13, v251
    v_add_u32 v13, 82144, v13
    s_lshl_b32 s34, s37, 5
    s_add_u32 s34, s34, s36
    s_lshl_b32 s34, s34, 6
    s_add_u32 s58, s34, 0x790000
    s_cmp_eq_u32 s3, 0
    s_cselect_b32 s58, s58, s6
    s_waitcnt vmcnt(0) lgkmcnt(0)
    s_barrier
    s_mul_i32 s28, s28, 1664525
    s_add_u32 s28, s28, 1013904223
    s_bitcmp1_b32 s51, 1
    s_cselect_b32 s34, 0, 16
    s_lshl_b32 s30, s30, s34
    s_and_b32 s30, s30, 0xffff0000
    s_mov_b32 s31, s30
    ds_read_b64_tr_b16 v[16:17], v13 offset:32
    ds_read_b64_tr_b16 v[18:19], v13 offset:0
    ds_read_b64_tr_b16 v[20:21], v13 offset:288
    ds_read_b64_tr_b16 v[22:23], v13 offset:256
    ds_read_b64_tr_b16 v[24:25], v13 offset:544
    ds_read_b64_tr_b16 v[26:27], v13 offset:512
    ds_read_b64_tr_b16 v[28:29], v13 offset:800
    ds_read_b64_tr_b16 v[30:31], v13 offset:768
    ds_read_b64_tr_b16 v[32:33], v13 offset:1056
    ds_read_b64_tr_b16 v[34:35], v13 offset:1024
    ds_read_b64_tr_b16 v[36:37], v13 offset:1312
    ds_read_b64_tr_b16 v[38:39], v13 offset:1280
    ds_read_b64_tr_b16 v[40:41], v13 offset:1568
    ds_read_b64_tr_b16 v[42:43], v13 offset:1536
    ds_read_b64_tr_b16 v[44:45], v13 offset:1824
    ds_read_b64_tr_b16 v[46:47], v13 offset:1792
    ds_read_b64_tr_b16 v[48:49], v13 offset:2080
    ds_read_b64_tr_b16 v[50:51], v13 offset:2048
    ds_read_b64_tr_b16 v[52:53], v13 offset:2336
    ds_read_b64_tr_b16 v[54:55], v13 offset:2304
    ds_read_b64_tr_b16 v[56:57], v13 offset:2592
    ds_read_b64_tr_b16 v[58:59], v13 offset:2560
    ds_read_b64_tr_b16 v[60:61], v13 offset:2848
    ds_read_b64_tr_b16 v[62:63], v13 offset:2816
    ds_read_b64_tr_b16 v[64:65], v13 offset:3104
    ds_read_b64_tr_b16 v[66:67], v13 offset:3072
    ds_read_b64_tr_b16 v[68:69], v13 offset:3360
    ds_read_b64_tr_b16 v[70:71], v13 offset:3328
    ds_read_b64_tr_b16 v[72:73], v13 offset:3616
    ds_read_b64_tr_b16 v[74:75], v13 offset:3584
    ds_read_b64_tr_b16 v[76:77], v13 offset:3872
    ds_read_b64_tr_b16 v[78:79], v13 offset:3840
    ds_read_b64_tr_b16 v[80:81], v13 offset:4160
    ds_read_b64_tr_b16 v[82:83], v13 offset:4128
    ds_read_b64_tr_b16 v[84:85], v13 offset:4416
    ds_read_b64_tr_b16 v[86:87], v13 offset:4384
    ds_read_b64_tr_b16 v[88:89], v13 offset:4672
    ds_read_b64_tr_b16 v[90:91], v13 offset:4640
    ds_read_b64_tr_b16 v[92:93], v13 offset:4928
    ds_read_b64_tr_b16 v[94:95], v13 offset:4896
    ds_read_b64_tr_b16 v[96:97], v13 offset:5184
    ds_read_b64_tr_b16 v[98:99], v13 offset:5152
    ds_read_b64_tr_b16 v[100:101], v13 offset:5440
    ds_read_b64_tr_b16 v[102:103], v13 offset:5408
    ds_read_b64_tr_b16 v[104:105], v13 offset:5696
    ds_read_b64_tr_b16 v[106:107], v13 offset:5664
    ds_read_b64_tr_b16 v[108:109], v13 offset:5952
    ds_read_b64_tr_b16 v[110:111], v13 offset:5920
    ds_read_b64_tr_b16 v[112:113], v13 offset:6208
    ds_read_b64_tr_b16 v[114:115], v13 offset:6176
    ds_read_b64_tr_b16 v[116:117], v13 offset:6464
    ds_read_b64_tr_b16 v[118:119], v13 offset:6432
    ds_read_b64_tr_b16 v[120:121], v13 offset:6720
    ds_read_b64_tr_b16 v[122:123], v13 offset:6688
    ds_read_b64_tr_b16 v[124:125], v13 offset:6976
    ds_read_b64_tr_b16 v[126:127], v13 offset:6944
    ds_read_b64_tr_b16 v[128:129], v13 offset:7232
    ds_read_b64_tr_b16 v[130:131], v13 offset:7200
    ds_read_b64_tr_b16 v[132:133], v13 offset:7488
    ds_read_b64_tr_b16 v[134:135], v13 offset:7456
    ds_read_b64_tr_b16 v[136:137], v13 offset:7744
    ds_read_b64_tr_b16 v[138:139], v13 offset:7712
    ds_read_b64_tr_b16 v[140:141], v13 offset:8000
    ds_read_b64_tr_b16 v[142:143], v13 offset:7968
    ds_read_b64_tr_b16 a[180:181], v13 offset:8288
    ds_read_b64_tr_b16 a[182:183], v13 offset:8256
    ds_read_b64_tr_b16 a[184:185], v13 offset:8544
    ds_read_b64_tr_b16 a[186:187], v13 offset:8512
    ds_read_b64_tr_b16 a[188:189], v13 offset:8800
    ds_read_b64_tr_b16 a[190:191], v13 offset:8768
    ds_read_b64_tr_b16 a[192:193], v13 offset:9056
    ds_read_b64_tr_b16 a[194:195], v13 offset:9024
    ds_read_b64_tr_b16 a[196:197], v13 offset:9312
    ds_read_b64_tr_b16 a[198:199], v13 offset:9280
    ds_read_b64_tr_b16 a[200:201], v13 offset:9568
    ds_read_b64_tr_b16 a[202:203], v13 offset:9536
    ds_read_b64_tr_b16 a[204:205], v13 offset:9824
    ds_read_b64_tr_b16 a[206:207], v13 offset:9792
    ds_read_b64_tr_b16 a[208:209], v13 offset:10080
    ds_read_b64_tr_b16 a[210:211], v13 offset:10048
    ds_read_b64_tr_b16 a[212:213], v13 offset:10336
    ds_read_b64_tr_b16 a[214:215], v13 offset:10304
    ds_read_b64_tr_b16 a[216:217], v13 offset:10592
    ds_read_b64_tr_b16 a[218:219], v13 offset:10560
    ds_read_b64_tr_b16 a[220:221], v13 offset:10848
    ds_read_b64_tr_b16 a[222:223], v13 offset:10816
    ds_read_b64_tr_b16 a[224:225], v13 offset:11104
    ds_read_b64_tr_b16 a[226:227], v13 offset:11072
    ds_read_b64_tr_b16 a[228:229], v13 offset:11360
    ds_read_b64_tr_b16 a[230:231], v13 offset:11328
    ds_read_b64_tr_b16 a[232:233], v13 offset:11616
    ds_read_b64_tr_b16 a[234:235], v13 offset:11584
    ds_read_b64_tr_b16 a[236:237], v13 offset:11872
    ds_read_b64_tr_b16 a[238:239], v13 offset:11840
    ds_read_b64_tr_b16 a[240:241], v13 offset:12128
    ds_read_b64_tr_b16 a[242:243], v13 offset:12096
    v_mov_b32 v0, s28
    v_mov_b32 v244, v12
    s_mov_b32 s84, s38
    v_lshrrev_b32 v248, 4, v1
    v_bfe_u32 v249, v1, 2, 2
    v_and_b32 v250, 3, v1
    v_lshlrev_b32 v2, 4, v1
    v_lshrrev_b32 v3, 1, v1
    v_lshlrev_b32 v3, 7, v3
    v_and_b32 v4, 1, v1
    v_lshrrev_b32 v10, 3, v1
    v_lshlrev_b32 v10, 7, v10
    v_lshl_add_u32 v10, v4, 6, v10
    v_lshl_add_u32 v3, v4, 5, v3
    v_bfe_u32 v4, v1, 1, 2
    v_lshl_add_u32 v10, v4, 4, v10
    v_lshl_add_u32 v4, v250, 2, v249
    v_lshlrev_b32 v4, 3, v4
    v_lshl_add_u32 v4, v248, 4, v4
    s_mul_i32 s41, s3, 3456
    s_add_u32 s34, s41, 49928
    s_add_u32 s41, s41, 50048
    v_add_u32 v4, s34, v4
    v_add_u32 v12, 1152, v4
    v_add_u32 v14, 2304, v4
    s_mul_i32 s34, s3, 4116
    v_lshl_add_u32 v5, v1, 2, s34
    s_mul_i32 s34, s3, 4112
    v_lshl_add_u32 v6, v250, 2, s34
    s_mul_i32 s34, s3, 16640
    v_lshl_add_u32 v7, v1, 5, s34
    s_mul_i32 s34, s3, 1152
    s_add_u32 s34, s34, 50048
    v_lshl_add_u32 v8, v1, 2, s34
    v_lshlrev_b32 v9, 5, v1
    v_add_u32 v9, 63744, v9
    v_lshlrev_b32 v11, 6, v1
    v_mov_b32 v15, 0
    s_and_b32 s34, s3, 1
    s_mul_i32 s34, s34, 49152
    s_mul_i32 s35, s48, 192
    s_add_u32 s34, s34, s35
    s_lshl_b32 s35, s49, 7
    s_add_u32 s35, s35, 0x500000
    s_add_u32 s59, s95, 0
    s_and_b32 s59, s59, 3
    s_mul_i32 s60, s59, 491520
    s_add_u32 s60, s60, s34
    s_mul_i32 s52, s59, 655360
    s_add_u32 s52, s52, s35
    s_add_u32 s59, s95, 1
    s_and_b32 s59, s59, 3
    s_mul_i32 s61, s59, 491520
    s_add_u32 s61, s61, s34
    s_mul_i32 s53, s59, 655360
    s_add_u32 s53, s53, s35
    s_add_u32 s59, s95, 2
    s_and_b32 s59, s59, 3
    s_mul_i32 s62, s59, 491520
    s_add_u32 s62, s62, s34
    s_mul_i32 s54, s59, 655360
    s_add_u32 s54, s54, s35
    s_add_u32 s59, s95, 3
    s_and_b32 s59, s59, 3
    s_mul_i32 s63, s59, 491520
    s_add_u32 s63, s63, s34
    s_mul_i32 s55, s59, 655360
    s_add_u32 s55, s55, s35
    s_lshl_b32 s40, s50, 12
    s_lshl_b32 s34, s3, 12
    s_add_u32 s35, s40, s34
    s_add_u32 s100, s35, 0x280000
    s_add_u32 s56, s35, 0x500000
    s_add_u32 s42, s34, 63744
    s_add_u32 s43, s34, 0x780000
    s_add_u32 s38, s34, 0x790000
    s_lshr_b32 s34, s3, 1
    s_lshl_b32 s34, s34, 6
    s_add_u32 s40, s40, s34
    s_and_b32 s34, s3, 1
    s_lshl_b32 s34, s34, 4
    s_add_u32 s40, s40, s34
    s_and_b32 s34, s2, 1
    s_lshl_b32 s34, s34, 2
    s_add_u32 s34, s34, s3
    s_cmp_eq_u32 s34, 6
    s_cselect_b32 s56, s6, s56
    s_cselect_b32 s100, s6, s100
    s_cmp_eq_u32 s3, 3
    s_cselect_b32 s100, s6, s100
    s_or_b32 s34, s2, s3
    s_cmp_eq_u32 s34, 0
    s_cselect_b32 s101, 0x79c000, s6
    s_lshl_b32 s34, s2, 6
    s_add_u32 s57, s34, 0x794000
    s_add_u32 s39, s34, 0x798000
    s_cmp_eq_u32 s3, 0
    s_cselect_b32 s57, s57, s6
    s_cselect_b32 s39, s39, s6
    v_add_u32 v208, 0, v1
    v_mul_u32_u24 v209, 171, v208
    v_lshrrev_b32 v209, 11, v209
    v_mul_u32_u24 v210, 12, v209
    v_sub_u32 v208, v208, v210
    v_bfe_u32 v210, v209, 2, 1
    v_lshlrev_b32 v210, 1, v210
    v_sub_u32 v208, v208, v210
    v_add_u32 v210, 12, v208
    v_min_u32 v208, v208, v210
    v_mul_u32_u24 v209, 3072, v209
    v_lshl_add_u32 v208, v208, 4, v209
    v_subrev_u32 v13, 0, v208
    v_add_u32 v208, 64, v1
    v_mul_u32_u24 v209, 171, v208
    v_lshrrev_b32 v209, 11, v209
    v_mul_u32_u24 v210, 12, v209
    v_sub_u32 v208, v208, v210
    v_bfe_u32 v210, v209, 2, 1
    v_lshlrev_b32 v210, 1, v210
    v_sub_u32 v208, v208, v210
    v_add_u32 v210, 12, v208
    v_min_u32 v208, v208, v210
    v_mul_u32_u24 v209, 3072, v209
    v_lshl_add_u32 v208, v208, 4, v209
    v_subrev_u32 v254, 1024, v208
    v_add_u32 v208, 128, v1
    v_mul_u32_u24 v209, 171, v208
    v_lshrrev_b32 v209, 11, v209
    v_mul_u32_u24 v210, 12, v209
    v_sub_u32 v208, v208, v210
    v_bfe_u32 v210, v209, 2, 1
    v_lshlrev_b32 v210, 1, v210
    v_sub_u32 v208, v208, v210
    v_add_u32 v210, 12, v208
    v_min_u32 v208, v208, v210
    v_mul_u32_u24 v209, 3072, v209
    v_lshl_add_u32 v208, v208, 4, v209
    v_subrev_u32 v255, 2048, v208
    v_lshl_add_u32 v208, v248, 2, v249
    v_mul_u32_u24 v208, 192, v208
    v_and_b32 v209, 1, v250
    v_lshl_add_u32 v208, v209, 3, v208
    v_and_b32 v209, 1, v248
    s_mul_i32 s34, s3, 3
    v_lshl_add_u32 v209, v209, 1, s34
    v_lshrrev_b32 v210, 1, v250
    v_add_u32 v211, v209, v210
    v_add_u32 v212, -12, v211
    v_min_u32 v211, v211, v212
    v_lshl_add_u32 v213, v211, 4, v208
    v_add_u32 v209, 2, v209
    v_add_u32 v212, -12, v209
    v_min_u32 v209, v209, v212
    v_lshl_add_u32 v214, v209, 4, v208
    v_mul_u32_u24 v210, 6144, v210
    v_add_u32 v214, v214, v210
    v_add_u32 v252, 90112, v213
    v_add_u32 v253, 90112, v214
    v_mov_b32 v204, 0x3f803f80
    v_mov_b32 v205, 0x3f803f80
    v_mov_b32 v206, 0x3f803f80
    v_mov_b32 v207, 0x3f803f80
    s_mul_i32 s80, s3, 3072
    s_cmp_ge_u32 s3, 2
    s_cselect_b32 s16, s20, s16
    s_cselect_b32 s17, s21, s17
    s_mul_i32 s82, s44, 24
    s_add_u32 s82, s82, s45
    s_mul_i32 s81, s82, 10240
    s_add_u32 s81, s81, 0xc00000
    s_lshl_b32 s82, s82, 6
    s_add_u32 s82, s82, 0x7c0000
    s_cmp_lt_u32 s2, 192
    s_cselect_b32 s34, s3, 0
    s_cmp_eq_u32 s34, 3
    s_cselect_b32 s82, s82, s6
gp_kernel_B2:
    s_waitcnt lgkmcnt(0)
    s_barrier
    s_mov_b64 exec, 1
    buffer_store_dword v0, v15, s[4:7], s58 offen sc1
    s_mov_b64 exec, -1
    s_add_u32 m0, s80, 0
    s_add_u32 s59, s60, 0
    buffer_load_dwordx4 v13, s[16:19], s59 offen offset:0  lds
    buffer_load_dwordx4 v254, s[16:19], s59 offen offset:1024  lds
    buffer_load_dwordx4 v255, s[16:19], s59 offen offset:2048  lds
    s_add_u32 m0, s80, 12288
    s_add_u32 s59, s60, 98304
    buffer_load_dwordx4 v13, s[16:19], s59 offen offset:0  lds
    buffer_load_dwordx4 v254, s[16:19], s59 offen offset:1024  lds
    buffer_load_dwordx4 v255, s[16:19], s59 offen offset:2048  lds
    s_add_u32 m0, s80, 24576
    s_add_u32 s59, s60, 196608
    buffer_load_dwordx4 v13, s[16:19], s59 offen offset:0  lds
    buffer_load_dwordx4 v254, s[16:19], s59 offen offset:1024  lds
    buffer_load_dwordx4 v255, s[16:19], s59 offen offset:2048  lds
    s_cmp_eq_u32 s82, s6
    s_cbranch_scc1 gp_kernel_nowt
    s_mov_b32 exec_hi, 0x0fffffff
    s_mov_b32 m0, 36864
    s_add_u32 s34, s84, 0
    buffer_load_dwordx4 v244, s[8:11], s34 offen nt lds
    s_mov_b32 m0, 37824
    s_add_u32 s34, s84, 7680
    buffer_load_dwordx4 v244, s[8:11], s34 offen nt lds
    s_mov_b32 m0, 38784
    s_add_u32 s34, s84, 15360
    buffer_load_dwordx4 v244, s[8:11], s34 offen nt lds
    s_mov_b32 m0, 39744
    s_add_u32 s34, s84, 23040
    buffer_load_dwordx4 v244, s[8:11], s34 offen nt lds
    s_mov_b32 m0, 40704
    s_add_u32 s34, s84, 30720
    buffer_load_dwordx4 v244, s[8:11], s34 offen nt lds
    s_mov_b32 m0, 41664
    s_add_u32 s34, s84, 38400
    buffer_load_dwordx4 v244, s[8:11], s34 offen nt lds
    s_mov_b32 m0, 42624
    s_add_u32 s34, s84, 46080
    buffer_load_dwordx4 v244, s[8:11], s34 offen nt lds
    s_mov_b32 m0, 43584
    s_add_u32 s34, s84, 53760
    buffer_load_dwordx4 v244, s[8:11], s34 offen nt lds
    s_mov_b32 m0, 44544
    s_add_u32 s34, s84, 61440
    buffer_load_dwordx4 v244, s[8:11], s34 offen nt lds
    s_mov_b32 m0, 45504
    s_add_u32 s34, s84, 69120
    buffer_load_dwordx4 v244, s[8:11], s34 offen nt lds
    s_mov_b32 exec_hi, 0xff
    s_mov_b32 m0, 46464
    s_add_u32 s34, s84, 76800
    buffer_load_dwordx4 v244, s[8:11], s34 offen nt lds
    s_mov_b32 exec_hi, -1
gp_kernel_nowt:
    s_mov_b32 s96, 0
gp_kernel_pF1:
    s_add_u32 s96, s96, 1
    buffer_load_dword v245, v11, s[4:7], s38 offen sc1
    s_waitcnt vmcnt(0)
    v_cmp_ne_u32 vcc, s28, v245
    s_nop 4
    s_cbranch_vccz gp_kernel_pF1d
    s_cmp_lt_u32 s96, 40000
    s_cbranch_scc1 gp_kernel_pF1
gp_kernel_pF1d:
    s_barrier
    s_add_u32 m0, s41, 0
    s_add_u32 s34, s40, 0
    buffer_load_dwordx4 v3, s[4:7], s34 offen sc1 lds
    s_add_u32 m0, s41, 1152
    s_add_u32 s34, s40, 4096
    buffer_load_dwordx4 v3, s[4:7], s34 offen sc1 lds
    s_add_u32 m0, s41, 2304
    s_add_u32 s34, s40, 8192
    buffer_load_dwordx4 v3, s[4:7], s34 offen sc1 lds
    s_mov_b32 m0, s42
    s_nop 0
    buffer_load_dwordx4 v2, s[4:7], s43 offen offset:0 sc1 lds
    buffer_load_dwordx4 v2, s[4:7], s43 offen offset:1024 sc1 lds
    buffer_load_dwordx4 v2, s[4:7], s43 offen offset:2048 sc1 lds
    buffer_load_dwordx4 v2, s[4:7], s43 offen offset:3072 sc1 lds
    buffer_load_dwordx4 v[228:231], v10, s[4:7], s100 offen offset:0 sc1
    buffer_load_dwordx4 v[232:235], v10, s[4:7], s100 offen offset:1024 sc1
    buffer_load_dwordx4 v[236:239], v10, s[4:7], s100 offen offset:2048 sc1
    buffer_load_dwordx4 v[240:243], v10, s[4:7], s100 offen offset:3072 sc1
    s_mov_b64 exec, 1
    buffer_store_dword v0, v15, s[4:7], s101 offen sc1
    s_mov_b64 exec, -1
    s_add_u32 m0, s80, 90112
    s_add_u32 s59, s60, 294912
    buffer_load_dwordx4 v13, s[16:19], s59 offen offset:0  lds
    buffer_load_dwordx4 v254, s[16:19], s59 offen offset:1024  lds
    buffer_load_dwordx4 v255, s[16:19], s59 offen offset:2048  lds
    s_add_u32 m0, s80, 102400
    s_add_u32 s59, s60, 393216
    buffer_load_dwordx4 v13, s[16:19], s59 offen offset:0  lds
    buffer_load_dwordx4 v254, s[16:19], s59 offen offset:1024  lds
    buffer_load_dwordx4 v255, s[16:19], s59 offen offset:2048  lds
    s_cmp_eq_u32 s82, s6
    s_cbranch_scc1 gp_kernel_nowr
    v_lshl_add_u32 v244, v248, 3, v249
    v_mul_u32_u24 v244, 160, v244
    v_mad_u32_u24 v244, v250, 40, v244
    v_add_u32 v244, 36864, v244
    ds_read_b64_tr_b16 a[140:141], v244 offset:0
    ds_read_b64_tr_b16 a[142:143], v244 offset:640
    ds_read_b64_tr_b16 a[144:145], v244 offset:8
    ds_read_b64_tr_b16 a[146:147], v244 offset:648
    ds_read_b64_tr_b16 a[148:149], v244 offset:16
    ds_read_b64_tr_b16 a[150:151], v244 offset:656
    ds_read_b64_tr_b16 a[152:153], v244 offset:24
    ds_read_b64_tr_b16 a[154:155], v244 offset:664
    ds_read_b64_tr_b16 a[156:157], v244 offset:32
    ds_read_b64_tr_b16 a[158:159], v244 offset:672
    ds_read_b64_tr_b16 a[160:161], v244 offset:5120
    ds_read_b64_tr_b16 a[162:163], v244 offset:5760
    ds_read_b64_tr_b16 a[164:165], v244 offset:5128
    ds_read_b64_tr_b16 a[166:167], v244 offset:5768
    ds_read_b64_tr_b16 a[168:169], v244 offset:5136
    ds_read_b64_tr_b16 a[170:171], v244 offset:5776
    ds_read_b64_tr_b16 a[172:173], v244 offset:5144
    ds_read_b64_tr_b16 a[174:175], v244 offset:5784
    ds_read_b64_tr_b16 a[176:177], v244 offset:5152
    ds_read_b64_tr_b16 a[178:179], v244 offset:5792
gp_kernel_nowr:
    ds_read_b64_tr_b16 a[0:1], v213 offset:0
    ds_read_b64_tr_b16 a[2:3], v213 offset:3072
    ds_read_b64_tr_b16 a[4:5], v213 offset:6144
    ds_read_b64_tr_b16 a[6:7], v213 offset:9216
    ds_read_b64_tr_b16 a[8:9], v214 offset:0
    ds_read_b64_tr_b16 a[10:11], v214 offset:3072
    ds_read_b64_tr_b16 a[12:13], v213 offset:12288
    ds_read_b64_tr_b16 a[14:15], v213 offset:15360
    ds_read_b64_tr_b16 a[16:17], v213 offset:18432
    ds_read_b64_tr_b16 a[18:19], v213 offset:21504
    ds_read_b64_tr_b16 a[20:21], v214 offset:12288
    ds_read_b64_tr_b16 a[22:23], v214 offset:15360
    ds_read_b64_tr_b16 a[24:25], v213 offset:24576
    ds_read_b64_tr_b16 a[26:27], v213 offset:27648
    ds_read_b64_tr_b16 a[28:29], v213 offset:30720
    ds_read_b64_tr_b16 a[30:31], v213 offset:33792
    ds_read_b64_tr_b16 a[32:33], v214 offset:24576
    ds_read_b64_tr_b16 a[34:35], v214 offset:27648
    s_waitcnt lgkmcnt(15)
    v_mfma_f32_16x16x32_bf16 a[244:247], a[0:3], v[204:207], 0
    s_waitcnt lgkmcnt(14)
    v_mfma_f32_16x16x32_bf16 a[248:251], a[4:7], v[204:207], 0
    s_waitcnt lgkmcnt(12)
    v_mfma_f32_16x16x32_bf16 a[252:255], a[8:11], v[204:207], 0
    s_waitcnt lgkmcnt(10)
    v_mfma_f32_16x16x32_bf16 a[244:247], a[12:15], v[204:207], a[244:247]
    s_waitcnt lgkmcnt(8)
    v_mfma_f32_16x16x32_bf16 a[248:251], a[16:19], v[204:207], a[248:251]
    s_waitcnt lgkmcnt(6)
    v_mfma_f32_16x16x32_bf16 a[252:255], a[20:23], v[204:207], a[252:255]
    s_waitcnt lgkmcnt(4)
    v_mfma_f32_16x16x32_bf16 a[244:247], a[24:27], v[204:207], a[244:247]
    s_waitcnt lgkmcnt(2)
    v_mfma_f32_16x16x32_bf16 a[248:251], a[28:31], v[204:207], a[248:251]
    s_waitcnt lgkmcnt(0)
    v_mfma_f32_16x16x32_bf16 a[252:255], a[32:35], v[204:207], a[252:255]
    s_waitcnt vmcnt(17)
    ds_read_b64 v[196:197], v4 offset:0
    ds_read_b64 v[198:199], v4 offset:8
    s_waitcnt vmcnt(16)
    ds_read_b64 v[200:201], v12 offset:0
    ds_read_b64 v[202:203], v12 offset:8
    s_waitcnt vmcnt(15)
    ds_read_b64 v[204:205], v14 offset:0
    ds_read_b64 v[206:207], v14 offset:8
    ds_read_b64 v[208:209], v4 offset:64
    ds_read_b64 v[210:211], v4 offset:72
    ds_read_b64 v[212:213], v12 offset:64
    ds_read_b64 v[214:215], v12 offset:72
    ds_read_b64 v[216:217], v14 offset:64
    ds_read_b64 v[218:219], v14 offset:72
    ds_read_b64 v[220:221], v4 offset:128
    ds_read_b64 v[222:223], v4 offset:136
    ds_read_b64 v[224:225], v12 offset:128
    ds_read_b64 v[226:227], v12 offset:136
    s_waitcnt lgkmcnt(14)
    v_mfma_f32_16x16x32_bf16 v[156:159], v[196:199], v[44:47], 0
    v_mfma_f32_16x16x32_bf16 v[152:155], v[196:199], v[36:39], 0
    v_mfma_f32_16x16x32_bf16 v[148:151], v[196:199], v[28:31], 0
    v_mfma_f32_16x16x32_bf16 v[144:147], v[196:199], v[20:23], 0
    ds_read_b64 v[196:197], v14 offset:128
    ds_read_b64 v[198:199], v14 offset:136
    s_waitcnt lgkmcnt(14)
    v_mfma_f32_16x16x32_bf16 v[172:175], v[200:203], v[108:111], 0
    v_mfma_f32_16x16x32_bf16 v[168:171], v[200:203], v[100:103], 0
    v_mfma_f32_16x16x32_bf16 v[164:167], v[200:203], v[92:95], 0
    v_mfma_f32_16x16x32_bf16 v[160:163], v[200:203], v[84:87], 0
    ds_read_b64 v[200:201], v4 offset:192
    ds_read_b64 v[202:203], v4 offset:200
    s_waitcnt lgkmcnt(14)
    v_mfma_f32_16x16x32_bf16 v[188:191], v[204:207], a[208:211], 0
    v_mfma_f32_16x16x32_bf16 v[184:187], v[204:207], a[200:203], 0
    v_mfma_f32_16x16x32_bf16 v[180:183], v[204:207], a[192:195], 0
    v_mfma_f32_16x16x32_bf16 v[176:179], v[204:207], a[184:187], 0
    ds_read_b64 v[204:205], v12 offset:192
    ds_read_b64 v[206:207], v12 offset:200
    s_waitcnt lgkmcnt(14)
    v_mfma_f32_16x16x32_bf16 v[156:159], v[208:211], v[40:43], v[156:159]
    v_mfma_f32_16x16x32_bf16 v[152:155], v[208:211], v[32:35], v[152:155]
    v_mfma_f32_16x16x32_bf16 v[148:151], v[208:211], v[24:27], v[148:151]
    v_mfma_f32_16x16x32_bf16 v[144:147], v[208:211], v[16:19], v[144:147]
    ds_read_b64 v[208:209], v14 offset:192
    ds_read_b64 v[210:211], v14 offset:200
    s_waitcnt lgkmcnt(14)
    v_mfma_f32_16x16x32_bf16 v[172:175], v[212:215], v[104:107], v[172:175]
    v_mfma_f32_16x16x32_bf16 v[168:171], v[212:215], v[96:99], v[168:171]
    v_mfma_f32_16x16x32_bf16 v[164:167], v[212:215], v[88:91], v[164:167]
    v_mfma_f32_16x16x32_bf16 v[160:163], v[212:215], v[80:83], v[160:163]
    ds_read_b64 v[212:213], v4 offset:256
    ds_read_b64 v[214:215], v4 offset:264
    s_waitcnt lgkmcnt(14)
    v_mfma_f32_16x16x32_bf16 v[188:191], v[216:219], a[204:207], v[188:191]
    v_mfma_f32_16x16x32_bf16 v[184:187], v[216:219], a[196:199], v[184:187]
    v_mfma_f32_16x16x32_bf16 v[180:183], v[216:219], a[188:191], v[180:183]
    v_mfma_f32_16x16x32_bf16 v[176:179], v[216:219], a[180:183], v[176:179]
    ds_read_b64 v[216:217], v12 offset:256
    ds_read_b64 v[218:219], v12 offset:264
    s_barrier
    ds_write_b32 v6, v15 offset:0
    ds_write_b32 v6, v15 offset:16640
    ds_write_b32 v6, v15 offset:33280
    s_waitcnt lgkmcnt(15)
    v_mfma_f32_16x16x32_bf16 v[156:159], v[220:223], v[36:39], v[156:159]
    s_add_u32 m0, s80, 114688
    s_add_u32 s59, s61, 0
    buffer_load_dwordx4 v13, s[16:19], s59 offen offset:0  lds
    ds_write2st64_b32 v5, v144, v145 offset0:0 offset1:1
    ds_write2st64_b32 v5, v146, v147 offset0:2 offset1:3
    v_mfma_f32_16x16x32_bf16 v[152:155], v[220:223], v[28:31], v[152:155]
    ds_write2st64_b32 v5, v160, v161 offset0:65 offset1:66
    ds_write2st64_b32 v5, v162, v163 offset0:67 offset1:68
    v_mfma_f32_16x16x32_bf16 v[148:151], v[220:223], v[20:23], v[148:151]
    buffer_load_dwordx4 v254, s[16:19], s59 offen offset:1024  lds
    ds_write2st64_b32 v5, v176, v177 offset0:130 offset1:131
    ds_write2st64_b32 v5, v178, v179 offset0:132 offset1:133
    ds_read_b64 v[220:221], v14 offset:256
    ds_read_b64 v[222:223], v14 offset:264
    v_mfma_f32_16x16x32_bf16 v[172:175], v[224:227], v[100:103], v[172:175]
    v_mfma_f32_16x16x32_bf16 v[168:171], v[224:227], v[92:95], v[168:171]
    v_mfma_f32_16x16x32_bf16 v[164:167], v[224:227], v[84:87], v[164:167]
    buffer_load_dwordx4 v255, s[16:19], s59 offen offset:2048  lds
    ds_read_b64 v[224:225], v4 offset:320
    ds_read_b64 v[226:227], v4 offset:328
    s_waitcnt lgkmcnt(15)
    v_mfma_f32_16x16x32_bf16 v[188:191], v[196:199], a[200:203], v[188:191]
    v_mfma_f32_16x16x32_bf16 v[184:187], v[196:199], a[192:195], v[184:187]
    v_mfma_f32_16x16x32_bf16 v[180:183], v[196:199], a[184:187], v[180:183]
    s_add_u32 m0, s80, 126976
    s_add_u32 s59, s61, 98304
    buffer_load_dwordx4 v13, s[16:19], s59 offen offset:0  lds
    ds_read_b64 v[196:197], v12 offset:320
    ds_read_b64 v[198:199], v12 offset:328
    v_mfma_f32_16x16x32_bf16 v[156:159], v[200:203], v[32:35], v[156:159]
    v_mfma_f32_16x16x32_bf16 v[152:155], v[200:203], v[24:27], v[152:155]
    v_mfma_f32_16x16x32_bf16 v[148:151], v[200:203], v[16:19], v[148:151]
    buffer_load_dwordx4 v254, s[16:19], s59 offen offset:1024  lds
    ds_read_b64 v[200:201], v14 offset:320
    ds_read_b64 v[202:203], v14 offset:328
    v_mfma_f32_16x16x32_bf16 v[172:175], v[204:207], v[96:99], v[172:175]
    v_mfma_f32_16x16x32_bf16 v[168:171], v[204:207], v[88:91], v[168:171]
    v_mfma_f32_16x16x32_bf16 v[164:167], v[204:207], v[80:83], v[164:167]
    buffer_load_dwordx4 v255, s[16:19], s59 offen offset:2048  lds
    ds_read_b64 v[204:205], v4 offset:384
    ds_read_b64 v[206:207], v4 offset:392
    v_mfma_f32_16x16x32_bf16 v[188:191], v[208:211], a[196:199], v[188:191]
    ds_write2st64_b32 v5, v148, v149 offset0:4 offset1:5
    ds_write2st64_b32 v5, v150, v151 offset0:6 offset1:7
    v_mfma_f32_16x16x32_bf16 v[184:187], v[208:211], a[188:191], v[184:187]
    v_mfma_f32_16x16x32_bf16 v[180:183], v[208:211], a[180:183], v[180:183]
    s_add_u32 m0, s80, 139264
    s_add_u32 s59, s61, 196608
    buffer_load_dwordx4 v13, s[16:19], s59 offen offset:0  lds
    ds_write2st64_b32 v5, v164, v165 offset0:69 offset1:70
    ds_write2st64_b32 v5, v166, v167 offset0:71 offset1:72
    ds_read_b64 v[208:209], v12 offset:384
    ds_read_b64 v[210:211], v12 offset:392
    v_mfma_f32_16x16x32_bf16 v[156:159], v[212:215], v[28:31], v[156:159]
    ds_write2st64_b32 v5, v180, v181 offset0:134 offset1:135
    ds_write2st64_b32 v5, v182, v183 offset0:136 offset1:137
    v_mfma_f32_16x16x32_bf16 v[152:155], v[212:215], v[20:23], v[152:155]
    ds_read_b64 v[212:213], v14 offset:384
    ds_read_b64 v[214:215], v14 offset:392
    s_waitcnt lgkmcnt(15)
    v_mfma_f32_16x16x32_bf16 v[172:175], v[216:219], v[92:95], v[172:175]
    buffer_load_dwordx4 v254, s[16:19], s59 offen offset:1024  lds
    v_mfma_f32_16x16x32_bf16 v[168:171], v[216:219], v[84:87], v[168:171]
    ds_read_b64 v[216:217], v4 offset:448
    ds_read_b64 v[218:219], v4 offset:456
    v_mfma_f32_16x16x32_bf16 v[188:191], v[220:223], a[192:195], v[188:191]
    v_mfma_f32_16x16x32_bf16 v[184:187], v[220:223], a[184:187], v[184:187]
    buffer_load_dwordx4 v255, s[16:19], s59 offen offset:2048  lds
    ds_read_b64 v[220:221], v12 offset:448
    ds_read_b64 v[222:223], v12 offset:456
    v_mfma_f32_16x16x32_bf16 v[156:159], v[224:227], v[24:27], v[156:159]
    v_mfma_f32_16x16x32_bf16 v[152:155], v[224:227], v[16:19], v[152:155]
    ds_read_b64 v[224:225], v14 offset:448
    ds_read_b64 v[226:227], v14 offset:456
    s_waitcnt lgkmcnt(15)
    v_mfma_f32_16x16x32_bf16 v[172:175], v[196:199], v[88:91], v[172:175]
    s_add_u32 m0, s80, 151552
    s_add_u32 s59, s61, 294912
    buffer_load_dwordx4 v13, s[16:19], s59 offen offset:0  lds
    v_mfma_f32_16x16x32_bf16 v[168:171], v[196:199], v[80:83], v[168:171]
    ds_write2st64_b32 v5, v152, v153 offset0:8 offset1:9
    ds_write2st64_b32 v5, v154, v155 offset0:10 offset1:11
    v_mfma_f32_16x16x32_bf16 v[188:191], v[200:203], a[188:191], v[188:191]
    v_mfma_f32_16x16x32_bf16 v[184:187], v[200:203], a[180:183], v[184:187]
    buffer_load_dwordx4 v254, s[16:19], s59 offen offset:1024  lds
    v_mfma_f32_16x16x32_bf16 v[156:159], v[204:207], v[20:23], v[156:159]
    s_waitcnt lgkmcnt(12)
    v_mfma_f32_16x16x32_bf16 v[172:175], v[208:211], v[84:87], v[172:175]
    ds_write2st64_b32 v5, v168, v169 offset0:73 offset1:74
    ds_write2st64_b32 v5, v170, v171 offset0:75 offset1:76
    s_waitcnt lgkmcnt(10)
    v_mfma_f32_16x16x32_bf16 v[188:191], v[212:215], a[184:187], v[188:191]
    buffer_load_dwordx4 v255, s[16:19], s59 offen offset:2048  lds
    ds_write2st64_b32 v5, v184, v185 offset0:138 offset1:139
    ds_write2st64_b32 v5, v186, v187 offset0:140 offset1:141
    s_waitcnt lgkmcnt(10)
    v_mfma_f32_16x16x32_bf16 v[156:159], v[216:219], v[16:19], v[156:159]
    s_waitcnt lgkmcnt(8)
    v_mfma_f32_16x16x32_bf16 v[172:175], v[220:223], v[80:83], v[172:175]
    s_waitcnt lgkmcnt(6)
    v_mfma_f32_16x16x32_bf16 v[188:191], v[224:227], a[180:183], v[188:191]
    s_nop 3
    ds_write2st64_b32 v5, v156, v157 offset0:12 offset1:13
    ds_write2st64_b32 v5, v158, v159 offset0:14 offset1:15
    v_mov_b32 v192, v159
    s_nop 1
    ds_write2st64_b32 v5, v172, v173 offset0:77 offset1:78
    ds_write2st64_b32 v5, v174, v175 offset0:79 offset1:80
    v_mov_b32 v193, v175
    ds_write2st64_b32 v5, v188, v189 offset0:142 offset1:143
    ds_write2st64_b32 v5, v190, v191 offset0:144 offset1:145
    v_mov_b32 v194, v191
    s_waitcnt vmcnt(19)
    s_waitcnt lgkmcnt(0)
    s_barrier
    s_cmp_eq_u32 s3, 3
    s_cbranch_scc1 gp_kernel_E3
    ds_read_b32 v196, v8 offset:0
    ds_read_b32 v197, v8 offset:3456
    ds_read_b32 v198, v8 offset:6912
    ds_read_b32 v199, v8 offset:10368
    ds_read_b128 v[144:147], v7 offset:0
    ds_read_b128 v[148:151], v7 offset:16
    ds_read_b128 v[152:155], v7 offset:4112
    ds_read_b128 v[156:159], v7 offset:4128
    ds_read_b128 v[160:163], v7 offset:8224
    ds_read_b128 v[164:167], v7 offset:8240
    ds_read_b128 v[168:171], v7 offset:12336
    ds_read_b128 v[172:175], v7 offset:12352
    ds_read_b128 v[176:179], v9 offset:0
    ds_read_b128 v[180:183], v9 offset:16
    ds_read_b128 v[184:187], v9 offset:8192
    ds_read_b128 v[188:191], v9 offset:8208
    ds_read_b32 v224, v8 offset:256
    ds_read_b32 v225, v8 offset:3712
    ds_read_b32 v226, v8 offset:7168
    ds_read_b32 v227, v8 offset:10624
    ds_read_b128 v[200:203], v7 offset:2048
    ds_read_b128 v[204:207], v7 offset:2064
    ds_read_b128 v[208:211], v7 offset:6160
    ds_read_b128 v[212:215], v7 offset:6176
    ds_read_b128 v[216:219], v7 offset:10272
    ds_read_b128 v[220:223], v7 offset:10288
    s_waitcnt lgkmcnt(15)
    v_lshlrev_b32 v244, 16, v196
    v_and_b32 v248, 0xffff0000, v196
    v_lshlrev_b32 v245, 16, v197
    v_and_b32 v249, 0xffff0000, v197
    v_lshlrev_b32 v246, 16, v198
    v_and_b32 v250, 0xffff0000, v198
    v_lshlrev_b32 v247, 16, v199
    v_and_b32 v251, 0xffff0000, v199
    v_pk_fma_f32 v[144:145], v[244:245], s[30:31], v[144:145]
    v_pk_fma_f32 v[146:147], v[246:247], s[30:31], v[146:147]
    v_pk_fma_f32 v[148:149], v[248:249], s[30:31], v[148:149]
    v_pk_fma_f32 v[150:151], v[250:251], s[30:31], v[150:151]
    v_lshlrev_b32 v244, 16, v228
    v_and_b32 v245, 0xffff0000, v228
    v_lshlrev_b32 v246, 16, v229
    v_and_b32 v247, 0xffff0000, v229
    v_lshlrev_b32 v248, 16, v230
    v_and_b32 v249, 0xffff0000, v230
    v_lshlrev_b32 v250, 16, v231
    v_and_b32 v251, 0xffff0000, v231
    v_pk_add_f32 v[144:145], v[144:145], v[152:153]
    v_pk_add_f32 v[146:147], v[146:147], v[154:155]
    v_pk_add_f32 v[148:149], v[148:149], v[156:157]
    v_pk_add_f32 v[150:151], v[150:151], v[158:159]
    ds_read_b128 v[152:155], v7 offset:14384
    ds_read_b128 v[156:159], v7 offset:14400
    v_pk_add_f32 v[144:145], v[144:145], v[160:161]
    v_pk_add_f32 v[146:147], v[146:147], v[162:163]
    v_pk_add_f32 v[148:149], v[148:149], v[164:165]
    v_pk_add_f32 v[150:151], v[150:151], v[166:167]
    s_waitcnt lgkmcnt(15)
    v_pk_add_f32 v[144:145], v[144:145], v[168:169]
    v_pk_add_f32 v[146:147], v[146:147], v[170:171]
    v_pk_add_f32 v[148:149], v[148:149], v[172:173]
    v_pk_add_f32 v[150:151], v[150:151], v[174:175]
    ds_read_b128 v[160:163], v9 offset:2048
    ds_read_b128 v[164:167], v9 offset:2064
    ds_read_b128 v[168:171], v9 offset:10240
    ds_read_b128 v[172:175], v9 offset:10256
    s_waitcnt lgkmcnt(15)
    v_pk_fma_f32 v[176:177], v[244:245], v[176:177], v[184:185]
    v_pk_fma_f32 v[178:179], v[246:247], v[178:179], v[186:187]
    v_pk_fma_f32 v[180:181], v[248:249], v[180:181], v[188:189]
    v_pk_fma_f32 v[182:183], v[250:251], v[182:183], v[190:191]
    v_pk_fma_f32 v[176:177], v[176:177], v[144:145], v[244:245]
    v_pk_fma_f32 v[178:179], v[178:179], v[146:147], v[246:247]
    v_pk_fma_f32 v[180:181], v[180:181], v[148:149], v[248:249]
    v_pk_fma_f32 v[182:183], v[182:183], v[150:151], v[250:251]
    v_cvt_pk_bf16_f32 v184, v176, v177
    v_cvt_pk_bf16_f32 v185, v178, v179
    v_cvt_pk_bf16_f32 v186, v180, v181
    v_cvt_pk_bf16_f32 v187, v182, v183
    buffer_store_dwordx4 v[184:187], v2, s[4:7], s56 offen offset:0 sc1
    s_waitcnt lgkmcnt(12)
    v_lshlrev_b32 v244, 16, v224
    v_and_b32 v248, 0xffff0000, v224
    v_lshlrev_b32 v245, 16, v225
    v_and_b32 v249, 0xffff0000, v225
    v_lshlrev_b32 v246, 16, v226
    v_and_b32 v250, 0xffff0000, v226
    v_lshlrev_b32 v247, 16, v227
    v_and_b32 v251, 0xffff0000, v227
    s_waitcnt lgkmcnt(10)
    v_pk_fma_f32 v[200:201], v[244:245], s[30:31], v[200:201]
    v_pk_fma_f32 v[202:203], v[246:247], s[30:31], v[202:203]
    v_pk_fma_f32 v[204:205], v[248:249], s[30:31], v[204:205]
    v_pk_fma_f32 v[206:207], v[250:251], s[30:31], v[206:207]
    v_lshlrev_b32 v244, 16, v232
    v_and_b32 v245, 0xffff0000, v232
    v_lshlrev_b32 v246, 16, v233
    v_and_b32 v247, 0xffff0000, v233
    v_lshlrev_b32 v248, 16, v234
    v_and_b32 v249, 0xffff0000, v234
    v_lshlrev_b32 v250, 16, v235
    v_and_b32 v251, 0xffff0000, v235
    s_waitcnt lgkmcnt(8)
    v_pk_add_f32 v[200:201], v[200:201], v[208:209]
    v_pk_add_f32 v[202:203], v[202:203], v[210:211]
    v_pk_add_f32 v[204:205], v[204:205], v[212:213]
    v_pk_add_f32 v[206:207], v[206:207], v[214:215]
    s_waitcnt lgkmcnt(6)
    v_pk_add_f32 v[200:201], v[200:201], v[216:217]
    v_pk_add_f32 v[202:203], v[202:203], v[218:219]
    v_pk_add_f32 v[204:205], v[204:205], v[220:221]
    v_pk_add_f32 v[206:207], v[206:207], v[222:223]
    s_waitcnt lgkmcnt(4)
    v_pk_add_f32 v[200:201], v[200:201], v[152:153]
    v_pk_add_f32 v[202:203], v[202:203], v[154:155]
    v_pk_add_f32 v[204:205], v[204:205], v[156:157]
    v_pk_add_f32 v[206:207], v[206:207], v[158:159]
    s_waitcnt lgkmcnt(0)
    v_pk_fma_f32 v[160:161], v[244:245], v[160:161], v[168:169]
    v_pk_fma_f32 v[162:163], v[246:247], v[162:163], v[170:171]
    v_pk_fma_f32 v[164:165], v[248:249], v[164:165], v[172:173]
    v_pk_fma_f32 v[166:167], v[250:251], v[166:167], v[174:175]
    v_pk_fma_f32 v[160:161], v[160:161], v[200:201], v[244:245]
    v_pk_fma_f32 v[162:163], v[162:163], v[202:203], v[246:247]
    v_pk_fma_f32 v[164:165], v[164:165], v[204:205], v[248:249]
    v_pk_fma_f32 v[166:167], v[166:167], v[206:207], v[250:251]
    v_cvt_pk_bf16_f32 v168, v160, v161
    v_cvt_pk_bf16_f32 v169, v162, v163
    v_cvt_pk_bf16_f32 v170, v164, v165
    v_cvt_pk_bf16_f32 v171, v166, v167
    buffer_store_dwordx4 v[168:171], v2, s[4:7], s56 offen offset:1024 sc1
    s_waitcnt vmcnt(2)
    s_branch gp_kernel_Em
gp_kernel_E3:
    s_waitcnt vmcnt(0)
    s_cmp_eq_u32 s82, s6
    s_cbranch_scc1 gp_kernel_Em
    buffer_store_dwordx4 a[140:143], v2, s[4:7], s81 offen offset:0 sc1
    buffer_store_dwordx4 a[144:147], v2, s[4:7], s81 offen offset:1024 sc1
    buffer_store_dwordx4 a[148:151], v2, s[4:7], s81 offen offset:2048 sc1
    buffer_store_dwordx4 a[152:155], v2, s[4:7], s81 offen offset:3072 sc1
    s_add_u32 s81, s81, 4096
    buffer_store_dwordx4 a[156:159], v2, s[4:7], s81 offen offset:0 sc1
    buffer_store_dwordx4 a[160:163], v2, s[4:7], s81 offen offset:1024 sc1
    buffer_store_dwordx4 a[164:167], v2, s[4:7], s81 offen offset:2048 sc1
    buffer_store_dwordx4 a[168:171], v2, s[4:7], s81 offen offset:3072 sc1
    s_add_u32 s81, s81, 4096
    buffer_store_dwordx4 a[172:175], v2, s[4:7], s81 offen offset:0 sc1
    buffer_store_dwordx4 a[176:179], v2, s[4:7], s81 offen offset:1024 sc1
gp_kernel_Em:
    s_barrier
    ds_read_b64 v[196:197], v4 offset:0
    ds_read_b64 v[198:199], v4 offset:8
    ds_read_b64 v[200:201], v12 offset:0
    ds_read_b64 v[202:203], v12 offset:8
    ds_read_b64 v[204:205], v14 offset:0
    ds_read_b64 v[206:207], v14 offset:8
    ds_read_b64 v[208:209], v4 offset:64
    ds_read_b64 v[210:211], v4 offset:72
    ds_read_b64 v[212:213], v12 offset:64
    ds_read_b64 v[214:215], v12 offset:72
    ds_read_b64 v[216:217], v14 offset:64
    ds_read_b64 v[218:219], v14 offset:72
    ds_read_b64 v[220:221], v4 offset:128
    ds_read_b64 v[222:223], v4 offset:136
    ds_read_b64 v[224:225], v12 offset:128
    ds_read_b64 v[226:227], v12 offset:136
    s_waitcnt lgkmcnt(14)
    v_mfma_f32_16x16x32_bf16 v[156:159], v[196:199], v[76:79], 0
    v_mfma_f32_16x16x32_bf16 v[152:155], v[196:199], v[68:71], 0
    ds_read_b64_tr_b16 a[36:37], v252 offset:0
    v_mfma_f32_16x16x32_bf16 v[148:151], v[196:199], v[60:63], 0
    ds_read_b64_tr_b16 a[38:39], v252 offset:3072
    v_mfma_f32_16x16x32_bf16 v[144:147], v[196:199], v[52:55], 0
    ds_read_b64_tr_b16 a[40:41], v252 offset:6144
    ds_read_b64 v[196:197], v14 offset:128
    ds_read_b64 v[198:199], v14 offset:136
    s_waitcnt lgkmcnt(15)
    v_mfma_f32_16x16x32_bf16 v[172:175], v[200:203], v[140:143], 0
    v_mfma_f32_16x16x32_bf16 v[168:171], v[200:203], v[132:135], 0
    ds_read_b64_tr_b16 a[42:43], v252 offset:9216
    v_mfma_f32_16x16x32_bf16 v[164:167], v[200:203], v[124:127], 0
    ds_read_b64_tr_b16 a[44:45], v253 offset:0
    v_mfma_f32_16x16x32_bf16 v[160:163], v[200:203], v[116:119], 0
    ds_read_b64_tr_b16 a[46:47], v253 offset:3072
    ds_read_b64 v[200:201], v4 offset:192
    ds_read_b64 v[202:203], v4 offset:200
    v_mfma_f32_16x16x32_bf16 v[188:191], v[204:207], a[240:243], 0
    v_mfma_f32_16x16x32_bf16 v[184:187], v[204:207], a[232:235], 0
    ds_read_b64_tr_b16 a[48:49], v252 offset:12288
    v_mfma_f32_16x16x32_bf16 v[180:183], v[204:207], a[224:227], 0
    ds_read_b64_tr_b16 a[50:51], v252 offset:15360
    v_mfma_f32_16x16x32_bf16 v[176:179], v[204:207], a[216:219], 0
    ds_read_b64_tr_b16 a[52:53], v252 offset:18432
    ds_read_b64 v[204:205], v12 offset:192
    ds_read_b64 v[206:207], v12 offset:200
    s_waitcnt lgkmcnt(15)
    v_mfma_f32_16x16x32_bf16 v[156:159], v[208:211], v[72:75], v[156:159]
    v_mfma_f32_16x16x32_bf16 v[152:155], v[208:211], v[64:67], v[152:155]
    ds_read_b64_tr_b16 a[54:55], v252 offset:21504
    v_mfma_f32_16x16x32_bf16 v[148:151], v[208:211], v[56:59], v[148:151]
    ds_read_b64_tr_b16 a[56:57], v253 offset:12288
    v_mfma_f32_16x16x32_bf16 v[144:147], v[208:211], v[48:51], v[144:147]
    ds_read_b64_tr_b16 a[58:59], v253 offset:15360
    ds_read_b64 v[208:209], v14 offset:192
    ds_read_b64 v[210:211], v14 offset:200
    v_mfma_f32_16x16x32_bf16 v[172:175], v[212:215], v[136:139], v[172:175]
    v_mfma_f32_16x16x32_bf16 v[168:171], v[212:215], v[128:131], v[168:171]
    ds_read_b64_tr_b16 a[60:61], v252 offset:24576
    v_mfma_f32_16x16x32_bf16 v[164:167], v[212:215], v[120:123], v[164:167]
    ds_read_b64_tr_b16 a[62:63], v252 offset:27648
    v_mfma_f32_16x16x32_bf16 v[160:163], v[212:215], v[112:115], v[160:163]
    ds_read_b64_tr_b16 a[64:65], v252 offset:30720
    ds_read_b64 v[212:213], v4 offset:256
    ds_read_b64 v[214:215], v4 offset:264
    v_mfma_f32_16x16x32_bf16 v[188:191], v[216:219], a[236:239], v[188:191]
    v_mfma_f32_16x16x32_bf16 v[184:187], v[216:219], a[228:231], v[184:187]
    ds_read_b64_tr_b16 a[66:67], v252 offset:33792
    v_mfma_f32_16x16x32_bf16 v[180:183], v[216:219], a[220:223], v[180:183]
    ds_read_b64_tr_b16 a[68:69], v253 offset:24576
    v_mfma_f32_16x16x32_bf16 v[176:179], v[216:219], a[212:215], v[176:179]
    ds_read_b64_tr_b16 a[70:71], v253 offset:27648
    ds_read_b64 v[216:217], v12 offset:256
    ds_read_b64 v[218:219], v12 offset:264
    v_mfma_f32_16x16x32_bf16 v[156:159], v[220:223], v[68:71], v[156:159]
    v_mfma_f32_16x16x32_bf16 v[152:155], v[220:223], v[60:63], v[152:155]
    ds_read_b64_tr_b16 a[72:73], v252 offset:36864
    v_mfma_f32_16x16x32_bf16 v[148:151], v[220:223], v[52:55], v[148:151]
    ds_read_b64_tr_b16 a[74:75], v252 offset:39936
    v_mfma_f32_16x16x32_bf16 v[144:147], v[220:223], v[44:47], v[144:147]
    ds_read_b64_tr_b16 a[76:77], v252 offset:43008
    ds_read_b64 v[220:221], v14 offset:256
    ds_read_b64 v[222:223], v14 offset:264
    v_mfma_f32_16x16x32_bf16 v[172:175], v[224:227], v[132:135], v[172:175]
    v_mfma_f32_16x16x32_bf16 v[168:171], v[224:227], v[124:127], v[168:171]
    ds_read_b64_tr_b16 a[78:79], v252 offset:46080
    v_mfma_f32_16x16x32_bf16 v[164:167], v[224:227], v[116:119], v[164:167]
    ds_read_b64_tr_b16 a[80:81], v253 offset:36864
    v_mfma_f32_16x16x32_bf16 v[160:163], v[224:227], v[108:111], v[160:163]
    ds_read_b64_tr_b16 a[82:83], v253 offset:39936
    ds_read_b64 v[224:225], v4 offset:320
    ds_read_b64 v[226:227], v4 offset:328
    s_waitcnt lgkmcnt(15)
    v_mfma_f32_16x16x32_bf16 v[188:191], v[196:199], a[232:235], v[188:191]
    v_mfma_f32_16x16x32_bf16 v[184:187], v[196:199], a[224:227], v[184:187]
    v_add_u32 v252, 49152, v252
    v_add_u32 v253, 49152, v253
    ds_read_b64_tr_b16 a[84:85], v252 offset:0
    v_mfma_f32_16x16x32_bf16 v[180:183], v[196:199], a[216:219], v[180:183]
    ds_read_b64_tr_b16 a[86:87], v252 offset:3072
    v_mfma_f32_16x16x32_bf16 v[176:179], v[196:199], a[208:211], v[176:179]
    ds_read_b64_tr_b16 a[88:89], v252 offset:6144
    ds_read_b64 v[196:197], v12 offset:320
    ds_read_b64 v[198:199], v12 offset:328
    ds_read_b64_tr_b16 a[90:91], v252 offset:9216
    ds_read_b64_tr_b16 a[92:93], v253 offset:0
    ds_read_b64_tr_b16 a[94:95], v253 offset:3072
    ds_read_b64_tr_b16 a[96:97], v252 offset:12288
    ds_read_b64_tr_b16 a[98:99], v252 offset:15360
    ds_read_b64_tr_b16 a[100:101], v252 offset:18432
    ds_read_b64_tr_b16 a[102:103], v252 offset:21504
    ds_read_b64_tr_b16 a[104:105], v253 offset:12288
    ds_read_b64_tr_b16 a[106:107], v253 offset:15360
    v_add_u32 v252, -49152, v252
    v_add_u32 v253, -49152, v253
    s_waitcnt lgkmcnt(0)
    s_barrier
    v_mfma_f32_16x16x32_bf16 v[156:159], v[200:203], v[64:67], v[156:159]
    s_add_u32 m0, s80, 90112
    s_add_u32 s59, s61, 393216
    buffer_load_dwordx4 v13, s[16:19], s59 offen offset:0  lds
    v_mfma_f32_16x16x32_bf16 v[152:155], v[200:203], v[56:59], v[152:155]
    v_mfma_f32_16x16x32_bf16 v[148:151], v[200:203], v[48:51], v[148:151]
    v_mfma_f32_16x16x32_bf16 v[144:147], v[200:203], v[40:43], v[144:147]
    buffer_load_dwordx4 v254, s[16:19], s59 offen offset:1024  lds
    ds_read_b64 v[200:201], v14 offset:320
    ds_read_b64 v[202:203], v14 offset:328
    v_mfma_f32_16x16x32_bf16 v[172:175], v[204:207], v[128:131], v[172:175]
    v_mfma_f32_16x16x32_bf16 v[168:171], v[204:207], v[120:123], v[168:171]
    v_mfma_f32_16x16x32_bf16 v[164:167], v[204:207], v[112:115], v[164:167]
    v_mfma_f32_16x16x32_bf16 v[160:163], v[204:207], v[104:107], v[160:163]
    buffer_load_dwordx4 v255, s[16:19], s59 offen offset:2048  lds
    ds_read_b64 v[204:205], v4 offset:384
    ds_read_b64 v[206:207], v4 offset:392
    v_mfma_f32_16x16x32_bf16 v[188:191], v[208:211], a[228:231], v[188:191]
    v_mfma_f32_16x16x32_bf16 v[184:187], v[208:211], a[220:223], v[184:187]
    v_mfma_f32_16x16x32_bf16 v[180:183], v[208:211], a[212:215], v[180:183]
    v_mfma_f32_16x16x32_bf16 v[176:179], v[208:211], a[204:207], v[176:179]
    s_add_u32 m0, s80, 102400
    s_add_u32 s59, s62, 0
    buffer_load_dwordx4 v13, s[16:19], s59 offen offset:0  lds
    ds_read_b64 v[208:209], v12 offset:384
    ds_read_b64 v[210:211], v12 offset:392
    s_waitcnt vmcnt(4)
    s_barrier
    s_mov_b64 exec, 1
    buffer_store_dword v0, v15, s[4:7], s57 offen sc1
    s_mov_b64 exec, -1
    v_mfma_f32_16x16x32_bf16 v[156:159], v[212:215], v[60:63], v[156:159]
    v_mfma_f32_16x16x32_bf16 v[152:155], v[212:215], v[52:55], v[152:155]
    v_mfma_f32_16x16x32_bf16 v[148:151], v[212:215], v[44:47], v[148:151]
    v_mfma_f32_16x16x32_bf16 v[144:147], v[212:215], v[36:39], v[144:147]
    buffer_load_dwordx4 v254, s[16:19], s59 offen offset:1024  lds
    ds_read_b64 v[212:213], v14 offset:384
    ds_read_b64 v[214:215], v14 offset:392
    v_mfma_f32_16x16x32_bf16 v[172:175], v[216:219], v[124:127], v[172:175]
    v_mfma_f32_16x16x32_bf16 v[168:171], v[216:219], v[116:119], v[168:171]
    v_mfma_f32_16x16x32_bf16 v[164:167], v[216:219], v[108:111], v[164:167]
    v_mfma_f32_16x16x32_bf16 v[160:163], v[216:219], v[100:103], v[160:163]
    buffer_load_dwordx4 v255, s[16:19], s59 offen offset:2048  lds
    ds_read_b64 v[216:217], v4 offset:448
    ds_read_b64 v[218:219], v4 offset:456
    v_mfma_f32_16x16x32_bf16 v[188:191], v[220:223], a[224:227], v[188:191]
    v_mfma_f32_16x16x32_bf16 v[184:187], v[220:223], a[216:219], v[184:187]
    v_mfma_f32_16x16x32_bf16 v[180:183], v[220:223], a[208:211], v[180:183]
    v_mfma_f32_16x16x32_bf16 v[176:179], v[220:223], a[200:203], v[176:179]
    s_add_u32 m0, s80, 114688
    s_add_u32 s59, s62, 98304
    buffer_load_dwordx4 v13, s[16:19], s59 offen offset:0  lds
    ds_read_b64 v[220:221], v12 offset:448
    ds_read_b64 v[222:223], v12 offset:456
    v_mfma_f32_16x16x32_bf16 v[156:159], v[224:227], v[56:59], v[156:159]
    v_mfma_f32_16x16x32_bf16 v[152:155], v[224:227], v[48:51], v[152:155]
    v_mfma_f32_16x16x32_bf16 v[148:151], v[224:227], v[40:43], v[148:151]
    v_mfma_f32_16x16x32_bf16 v[144:147], v[224:227], v[32:35], v[144:147]
    buffer_load_dwordx4 v254, s[16:19], s59 offen offset:1024  lds
    ds_read_b64 v[224:225], v14 offset:448
    ds_read_b64 v[226:227], v14 offset:456
    v_mfma_f32_16x16x32_bf16 v[172:175], v[196:199], v[120:123], v[172:175]
    v_mfma_f32_16x16x32_bf16 v[168:171], v[196:199], v[112:115], v[168:171]
    v_mfma_f32_16x16x32_bf16 v[164:167], v[196:199], v[104:107], v[164:167]
    v_mfma_f32_16x16x32_bf16 v[160:163], v[196:199], v[96:99], v[160:163]
    buffer_load_dwordx4 v255, s[16:19], s59 offen offset:2048  lds
    ds_read_b64 v[196:197], v4 offset:512
    ds_read_b64 v[198:199], v4 offset:520
    s_waitcnt lgkmcnt(14)
    v_mfma_f32_16x16x32_bf16 v[188:191], v[200:203], a[220:223], v[188:191]
    v_mfma_f32_16x16x32_bf16 v[184:187], v[200:203], a[212:215], v[184:187]
    v_mfma_f32_16x16x32_bf16 v[180:183], v[200:203], a[204:207], v[180:183]
    v_mfma_f32_16x16x32_bf16 v[176:179], v[200:203], a[196:199], v[176:179]
    s_add_u32 m0, s80, 126976
    s_add_u32 s59, s62, 196608
    buffer_load_dwordx4 v13, s[16:19], s59 offen offset:0  lds
    ds_read_b64 v[200:201], v12 offset:512
    ds_read_b64 v[202:203], v12 offset:520
    s_waitcnt lgkmcnt(14)
    v_mfma_f32_16x16x32_bf16 v[156:159], v[204:207], v[52:55], v[156:159]
    v_mfma_f32_16x16x32_bf16 v[152:155], v[204:207], v[44:47], v[152:155]
    v_mfma_f32_16x16x32_bf16 v[148:151], v[204:207], v[36:39], v[148:151]
    v_mfma_f32_16x16x32_bf16 v[144:147], v[204:207], v[28:31], v[144:147]
    buffer_load_dwordx4 v254, s[16:19], s59 offen offset:1024  lds
    ds_read_b64 v[204:205], v14 offset:512
    ds_read_b64 v[206:207], v14 offset:520
    s_waitcnt lgkmcnt(14)
    v_mfma_f32_16x16x32_bf16 v[172:175], v[208:211], v[116:119], v[172:175]
    v_mfma_f32_16x16x32_bf16 v[168:171], v[208:211], v[108:111], v[168:171]
    v_mfma_f32_16x16x32_bf16 v[164:167], v[208:211], v[100:103], v[164:167]
    v_mfma_f32_16x16x32_bf16 v[160:163], v[208:211], v[92:95], v[160:163]
    buffer_load_dwordx4 v255, s[16:19], s59 offen offset:2048  lds
    ds_read_b64 v[208:209], v4 offset:576
    ds_read_b64 v[210:211], v4 offset:584
    s_waitcnt lgkmcnt(14)
    v_mfma_f32_16x16x32_bf16 v[188:191], v[212:215], a[216:219], v[188:191]
    v_mfma_f32_16x16x32_bf16 v[184:187], v[212:215], a[208:211], v[184:187]
    v_mfma_f32_16x16x32_bf16 v[180:183], v[212:215], a[200:203], v[180:183]
    v_mfma_f32_16x16x32_bf16 v[176:179], v[212:215], a[192:195], v[176:179]
    s_add_u32 m0, s80, 139264
    s_add_u32 s59, s62, 294912
    buffer_load_dwordx4 v13, s[16:19], s59 offen offset:0  lds
    ds_read_b64 v[212:213], v12 offset:576
    ds_read_b64 v[214:215], v12 offset:584
    s_waitcnt lgkmcnt(14)
    v_mfma_f32_16x16x32_bf16 v[156:159], v[216:219], v[48:51], v[156:159]
    v_mfma_f32_16x16x32_bf16 v[152:155], v[216:219], v[40:43], v[152:155]
    v_mfma_f32_16x16x32_bf16 v[148:151], v[216:219], v[32:35], v[148:151]
    v_mfma_f32_16x16x32_bf16 v[144:147], v[216:219], v[24:27], v[144:147]
    buffer_load_dwordx4 v254, s[16:19], s59 offen offset:1024  lds
    ds_read_b64 v[216:217], v14 offset:576
    ds_read_b64 v[218:219], v14 offset:584
    s_waitcnt lgkmcnt(14)
    v_mfma_f32_16x16x32_bf16 v[172:175], v[220:223], v[112:115], v[172:175]
    v_mfma_f32_16x16x32_bf16 v[168:171], v[220:223], v[104:107], v[168:171]
    v_mfma_f32_16x16x32_bf16 v[164:167], v[220:223], v[96:99], v[164:167]
    v_mfma_f32_16x16x32_bf16 v[160:163], v[220:223], v[88:91], v[160:163]
    buffer_load_dwordx4 v255, s[16:19], s59 offen offset:2048  lds
    ds_read_b64 v[220:221], v4 offset:640
    ds_read_b64 v[222:223], v4 offset:648
    s_waitcnt lgkmcnt(14)
    v_mfma_f32_16x16x32_bf16 v[188:191], v[224:227], a[212:215], v[188:191]
    v_mfma_f32_16x16x32_bf16 v[184:187], v[224:227], a[204:207], v[184:187]
    v_mfma_f32_16x16x32_bf16 v[180:183], v[224:227], a[196:199], v[180:183]
    v_mfma_f32_16x16x32_bf16 v[176:179], v[224:227], a[188:191], v[176:179]
    s_add_u32 m0, s80, 151552
    s_add_u32 s59, s62, 393216
    buffer_load_dwordx4 v13, s[16:19], s59 offen offset:0  lds
    ds_read_b64 v[224:225], v12 offset:640
    ds_read_b64 v[226:227], v12 offset:648
    s_waitcnt lgkmcnt(14)
    v_mfma_f32_16x16x32_bf16 v[156:159], v[196:199], v[44:47], v[156:159]
    v_mfma_f32_16x16x32_bf16 v[152:155], v[196:199], v[36:39], v[152:155]
    v_mfma_f32_16x16x32_bf16 v[148:151], v[196:199], v[28:31], v[148:151]
    v_mfma_f32_16x16x32_bf16 v[144:147], v[196:199], v[20:23], v[144:147]
    buffer_load_dwordx4 v254, s[16:19], s59 offen offset:1024  lds
    ds_read_b64 v[196:197], v14 offset:640
    ds_read_b64 v[198:199], v14 offset:648
    s_waitcnt lgkmcnt(14)
    v_mfma_f32_16x16x32_bf16 v[172:175], v[200:203], v[108:111], v[172:175]
    v_mfma_f32_16x16x32_bf16 v[168:171], v[200:203], v[100:103], v[168:171]
    v_mfma_f32_16x16x32_bf16 v[164:167], v[200:203], v[92:95], v[164:167]
    v_mfma_f32_16x16x32_bf16 v[160:163], v[200:203], v[84:87], v[160:163]
    buffer_load_dwordx4 v255, s[16:19], s59 offen offset:2048  lds
    ds_read_b64 v[200:201], v4 offset:704
    ds_read_b64 v[202:203], v4 offset:712
    s_waitcnt lgkmcnt(14)
    v_mfma_f32_16x16x32_bf16 v[188:191], v[204:207], a[208:211], v[188:191]
    v_mfma_f32_16x16x32_bf16 v[184:187], v[204:207], a[200:203], v[184:187]
    v_mfma_f32_16x16x32_bf16 v[180:183], v[204:207], a[192:195], v[180:183]
    v_mfma_f32_16x16x32_bf16 v[176:179], v[204:207], a[184:187], v[176:179]
    v_lshrrev_b32 v3, 3, v1
    ds_read_b64 v[204:205], v12 offset:704
    ds_read_b64 v[206:207], v12 offset:712
    s_waitcnt lgkmcnt(14)
    v_mfma_f32_16x16x32_bf16 v[156:159], v[208:211], v[40:43], v[156:159]
    v_mfma_f32_16x16x32_bf16 v[152:155], v[208:211], v[32:35], v[152:155]
    v_mfma_f32_16x16x32_bf16 v[148:151], v[208:211], v[24:27], v[148:151]
    v_mfma_f32_16x16x32_bf16 v[144:147], v[208:211], v[16:19], v[144:147]
    v_lshlrev_b32 v3, 12, v3
    ds_read_b64 v[208:209], v14 offset:704
    ds_read_b64 v[210:211], v14 offset:712
    s_waitcnt lgkmcnt(14)
    v_mfma_f32_16x16x32_bf16 v[172:175], v[212:215], v[104:107], v[172:175]
    v_mfma_f32_16x16x32_bf16 v[168:171], v[212:215], v[96:99], v[168:171]
    v_mfma_f32_16x16x32_bf16 v[164:167], v[212:215], v[88:91], v[164:167]
    v_mfma_f32_16x16x32_bf16 v[160:163], v[212:215], v[80:83], v[160:163]
    v_bfe_u32 v244, v1, 4, 2
    ds_read_b64 v[212:213], v4 offset:768
    ds_read_b64 v[214:215], v4 offset:776
    s_waitcnt lgkmcnt(14)
    v_mfma_f32_16x16x32_bf16 v[188:191], v[216:219], a[204:207], v[188:191]
    v_mfma_f32_16x16x32_bf16 v[184:187], v[216:219], a[196:199], v[184:187]
    v_mfma_f32_16x16x32_bf16 v[180:183], v[216:219], a[188:191], v[180:183]
    v_mfma_f32_16x16x32_bf16 v[176:179], v[216:219], a[180:183], v[176:179]
    v_lshlrev_b32 v244, 1, v244
    ds_read_b64 v[216:217], v12 offset:768
    ds_read_b64 v[218:219], v12 offset:776
    v_add_u32 v195, -256, v5
    s_lshr_b64 s[34:35], -1, s3
    s_not_b64 exec, s[34:35]
    ds_write_b32 v195, v192 offset:0
    ds_write_b32 v195, v193 offset:16640
    ds_write_b32 v195, v194 offset:33280
    s_mov_b64 exec, -1
    s_waitcnt lgkmcnt(15)
    v_mfma_f32_16x16x32_bf16 v[156:159], v[220:223], v[36:39], v[156:159]
    ds_write2st64_b32 v5, v144, v145 offset0:0 offset1:1
    ds_write2st64_b32 v5, v146, v147 offset0:2 offset1:3
    v_mfma_f32_16x16x32_bf16 v[152:155], v[220:223], v[28:31], v[152:155]
    ds_write2st64_b32 v5, v160, v161 offset0:65 offset1:66
    ds_write2st64_b32 v5, v162, v163 offset0:67 offset1:68
    v_mfma_f32_16x16x32_bf16 v[148:151], v[220:223], v[20:23], v[148:151]
    ds_write2st64_b32 v5, v176, v177 offset0:130 offset1:131
    ds_write2st64_b32 v5, v178, v179 offset0:132 offset1:133
    ds_read_b64 v[220:221], v14 offset:768
    ds_read_b64 v[222:223], v14 offset:776
    v_mfma_f32_16x16x32_bf16 v[172:175], v[224:227], v[100:103], v[172:175]
    v_and_b32 v245, 7, v1
    v_mfma_f32_16x16x32_bf16 v[168:171], v[224:227], v[92:95], v[168:171]
    v_mfma_f32_16x16x32_bf16 v[164:167], v[224:227], v[84:87], v[164:167]
    ds_read_b64 v[224:225], v4 offset:832
    ds_read_b64 v[226:227], v4 offset:840
    s_waitcnt lgkmcnt(15)
    v_mfma_f32_16x16x32_bf16 v[188:191], v[196:199], a[200:203], v[188:191]
    v_mfma_f32_16x16x32_bf16 v[184:187], v[196:199], a[192:195], v[184:187]
    v_xor_b32 v244, v244, v245
    v_mfma_f32_16x16x32_bf16 v[180:183], v[196:199], a[184:187], v[180:183]
    ds_read_b64 v[196:197], v12 offset:832
    ds_read_b64 v[198:199], v12 offset:840
    v_mfma_f32_16x16x32_bf16 v[156:159], v[200:203], v[32:35], v[156:159]
    v_mfma_f32_16x16x32_bf16 v[152:155], v[200:203], v[24:27], v[152:155]
    v_mfma_f32_16x16x32_bf16 v[148:151], v[200:203], v[16:19], v[148:151]
    v_lshl_add_u32 v3, v244, 4, v3
    ds_read_b64 v[200:201], v14 offset:832
    ds_read_b64 v[202:203], v14 offset:840
    v_mfma_f32_16x16x32_bf16 v[172:175], v[204:207], v[96:99], v[172:175]
    v_mfma_f32_16x16x32_bf16 v[168:171], v[204:207], v[88:91], v[168:171]
    v_mfma_f32_16x16x32_bf16 v[164:167], v[204:207], v[80:83], v[164:167]
    ds_read_b64 v[204:205], v4 offset:896
    ds_read_b64 v[206:207], v4 offset:904
    v_mfma_f32_16x16x32_bf16 v[188:191], v[208:211], a[196:199], v[188:191]
    ds_write2st64_b32 v5, v148, v149 offset0:4 offset1:5
    ds_write2st64_b32 v5, v150, v151 offset0:6 offset1:7
    v_mfma_f32_16x16x32_bf16 v[184:187], v[208:211], a[188:191], v[184:187]
    v_mfma_f32_16x16x32_bf16 v[180:183], v[208:211], a[180:183], v[180:183]
    ds_read_b64 v[208:209], v12 offset:896
    ds_read_b64 v[210:211], v12 offset:904
    v_mfma_f32_16x16x32_bf16 v[156:159], v[212:215], v[28:31], v[156:159]
    ds_write2st64_b32 v5, v164, v165 offset0:69 offset1:70
    ds_write2st64_b32 v5, v166, v167 offset0:71 offset1:72
    v_mfma_f32_16x16x32_bf16 v[152:155], v[212:215], v[20:23], v[152:155]
    ds_read_b64 v[212:213], v14 offset:896
    ds_read_b64 v[214:215], v14 offset:904
    s_waitcnt lgkmcnt(15)
    v_mfma_f32_16x16x32_bf16 v[172:175], v[216:219], v[92:95], v[172:175]
    ds_write2st64_b32 v5, v180, v181 offset0:134 offset1:135
    ds_write2st64_b32 v5, v182, v183 offset0:136 offset1:137
    v_mfma_f32_16x16x32_bf16 v[168:171], v[216:219], v[84:87], v[168:171]
    ds_read_b64 v[216:217], v4 offset:960
    ds_read_b64 v[218:219], v4 offset:968
    v_mfma_f32_16x16x32_bf16 v[188:191], v[220:223], a[192:195], v[188:191]
    v_mfma_f32_16x16x32_bf16 v[184:187], v[220:223], a[184:187], v[184:187]
    ds_read_b64 v[220:221], v12 offset:960
    ds_read_b64 v[222:223], v12 offset:968
    s_waitcnt vmcnt(0)
    s_barrier
    s_waitcnt lgkmcnt(15)
    v_mfma_f32_16x16x32_bf16 v[156:159], v[224:227], v[24:27], v[156:159]
    ds_read_b64_tr_b16 a[108:109], v252 offset:0
    ds_read_b64_tr_b16 a[110:111], v252 offset:3072
    v_mfma_f32_16x16x32_bf16 v[152:155], v[224:227], v[16:19], v[152:155]
    ds_read_b64_tr_b16 a[112:113], v252 offset:6144
    ds_read_b64 v[224:225], v14 offset:960
    ds_read_b64 v[226:227], v14 offset:968
    v_mfma_f32_16x16x32_bf16 v[172:175], v[196:199], v[88:91], v[172:175]
    ds_read_b64_tr_b16 a[114:115], v252 offset:9216
    v_mfma_f32_16x16x32_bf16 v[168:171], v[196:199], v[80:83], v[168:171]
    ds_read_b64_tr_b16 a[116:117], v253 offset:0
    v_mfma_f32_16x16x32_bf16 v[188:191], v[200:203], a[188:191], v[188:191]
    ds_read_b64_tr_b16 a[118:119], v253 offset:3072
    ds_write2st64_b32 v5, v152, v153 offset0:8 offset1:9
    ds_write2st64_b32 v5, v154, v155 offset0:10 offset1:11
    v_mfma_f32_16x16x32_bf16 v[184:187], v[200:203], a[180:183], v[184:187]
    ds_read_b64_tr_b16 a[120:121], v252 offset:12288
    s_waitcnt lgkmcnt(15)
    v_mfma_f32_16x16x32_bf16 v[156:159], v[204:207], v[20:23], v[156:159]
    ds_read_b64_tr_b16 a[122:123], v252 offset:15360
    ds_write2st64_b32 v5, v168, v169 offset0:73 offset1:74
    ds_write2st64_b32 v5, v170, v171 offset0:75 offset1:76
    v_mfma_f32_16x16x32_bf16 v[172:175], v[208:211], v[84:87], v[172:175]
    ds_read_b64_tr_b16 a[124:125], v252 offset:18432
    ds_write2st64_b32 v5, v184, v185 offset0:138 offset1:139
    ds_write2st64_b32 v5, v186, v187 offset0:140 offset1:141
    v_mfma_f32_16x16x32_bf16 v[188:191], v[212:215], a[184:187], v[188:191]
    ds_read_b64_tr_b16 a[126:127], v252 offset:21504
    s_waitcnt lgkmcnt(15)
    v_mfma_f32_16x16x32_bf16 v[156:159], v[216:219], v[16:19], v[156:159]
    ds_read_b64_tr_b16 a[128:129], v253 offset:12288
    v_mfma_f32_16x16x32_bf16 v[172:175], v[220:223], v[80:83], v[172:175]
    ds_read_b64_tr_b16 a[130:131], v253 offset:15360
    s_waitcnt lgkmcnt(15)
    v_mfma_f32_16x16x32_bf16 v[188:191], v[224:227], a[180:183], v[188:191]
    ds_read_b64_tr_b16 a[132:133], v252 offset:24576
    ds_read_b64_tr_b16 a[134:135], v252 offset:27648
    ds_read_b64_tr_b16 a[136:137], v252 offset:30720
    ds_read_b64_tr_b16 a[138:139], v252 offset:33792
    ds_read_b64_tr_b16 a[140:141], v253 offset:24576
    ds_read_b64_tr_b16 a[142:143], v253 offset:27648
    ds_read_b64_tr_b16 a[144:145], v252 offset:36864
    ds_read_b64_tr_b16 a[146:147], v252 offset:39936
    ds_read_b64_tr_b16 a[148:149], v252 offset:43008
    ds_read_b64_tr_b16 a[150:151], v252 offset:46080
    ds_read_b64_tr_b16 a[152:153], v253 offset:36864
    ds_read_b64_tr_b16 a[154:155], v253 offset:39936
    v_add_u32 v252, 49152, v252
    v_add_u32 v253, 49152, v253
    ds_read_b64_tr_b16 a[156:157], v252 offset:0
    ds_read_b64_tr_b16 a[158:159], v252 offset:3072
    ds_read_b64_tr_b16 a[160:161], v252 offset:6144
    ds_read_b64_tr_b16 a[162:163], v252 offset:9216
    ds_read_b64_tr_b16 a[164:165], v253 offset:0
    ds_read_b64_tr_b16 a[166:167], v253 offset:3072
    ds_read_b64_tr_b16 a[168:169], v252 offset:12288
    ds_read_b64_tr_b16 a[170:171], v252 offset:15360
    ds_read_b64_tr_b16 a[172:173], v252 offset:18432
    ds_read_b64_tr_b16 a[174:175], v252 offset:21504
    ds_read_b64_tr_b16 a[176:177], v253 offset:12288
    ds_read_b64_tr_b16 a[178:179], v253 offset:15360
    v_add_u32 v252, -49152, v252
    v_add_u32 v253, -49152, v253
    ds_write2st64_b32 v5, v156, v157 offset0:12 offset1:13
    ds_write2st64_b32 v5, v158, v159 offset0:14 offset1:15
    ds_write2st64_b32 v5, v172, v173 offset0:77 offset1:78
    ds_write2st64_b32 v5, v174, v175 offset0:79 offset1:80
    ds_write2st64_b32 v5, v188, v189 offset0:142 offset1:143
    ds_write2st64_b32 v5, v190, v191 offset0:144 offset1:145
    s_waitcnt lgkmcnt(0)
    s_barrier
    s_add_u32 m0, s80, 90112
    s_add_u32 s59, s63, 0
    buffer_load_dwordx4 v13, s[16:19], s59 offen offset:0  lds
    buffer_load_dwordx4 v254, s[16:19], s59 offen offset:1024  lds
    buffer_load_dwordx4 v255, s[16:19], s59 offen offset:2048  lds
    s_add_u32 m0, s80, 102400
    s_add_u32 s59, s63, 98304
    buffer_load_dwordx4 v13, s[16:19], s59 offen offset:0  lds
    buffer_load_dwordx4 v254, s[16:19], s59 offen offset:1024  lds
    buffer_load_dwordx4 v255, s[16:19], s59 offen offset:2048  lds
    s_add_u32 m0, s80, 114688
    s_add_u32 s59, s63, 196608
    buffer_load_dwordx4 v13, s[16:19], s59 offen offset:0  lds
    buffer_load_dwordx4 v254, s[16:19], s59 offen offset:1024  lds
    buffer_load_dwordx4 v255, s[16:19], s59 offen offset:2048  lds
    s_add_u32 m0, s80, 126976
    s_add_u32 s59, s63, 294912
    buffer_load_dwordx4 v13, s[16:19], s59 offen offset:0  lds
    buffer_load_dwordx4 v254, s[16:19], s59 offen offset:1024  lds
    buffer_load_dwordx4 v255, s[16:19], s59 offen offset:2048  lds
    s_add_u32 m0, s80, 139264
    s_add_u32 s59, s63, 393216
    buffer_load_dwordx4 v13, s[16:19], s59 offen offset:0  lds
    buffer_load_dwordx4 v254, s[16:19], s59 offen offset:1024  lds
    buffer_load_dwordx4 v255, s[16:19], s59 offen offset:2048  lds
    s_cmp_eq_u32 s3, 3
    s_cbranch_scc1 gp_kernel_L3
    ds_read_b32 v196, v8 offset:512
    ds_read_b32 v197, v8 offset:3968
    ds_read_b32 v198, v8 offset:7424
    ds_read_b32 v199, v8 offset:10880
    ds_read_b128 v[144:147], v7 offset:0
    ds_read_b128 v[148:151], v7 offset:16
    ds_read_b128 v[152:155], v7 offset:4112
    ds_read_b128 v[156:159], v7 offset:4128
    ds_read_b128 v[160:163], v7 offset:8224
    ds_read_b128 v[164:167], v7 offset:8240
    ds_read_b128 v[168:171], v7 offset:12336
    ds_read_b128 v[172:175], v7 offset:12352
    ds_read_b128 v[176:179], v9 offset:4096
    ds_read_b128 v[180:183], v9 offset:4112
    ds_read_b128 v[184:187], v9 offset:12288
    ds_read_b128 v[188:191], v9 offset:12304
    ds_read_b32 v224, v8 offset:768
    ds_read_b32 v225, v8 offset:4224
    ds_read_b32 v226, v8 offset:7680
    ds_read_b32 v227, v8 offset:11136
    ds_read_b128 v[200:203], v7 offset:2048
    ds_read_b128 v[204:207], v7 offset:2064
    ds_read_b128 v[208:211], v7 offset:6160
    ds_read_b128 v[212:215], v7 offset:6176
    ds_read_b128 v[216:219], v7 offset:10272
    ds_read_b128 v[220:223], v7 offset:10288
    s_waitcnt lgkmcnt(15)
    v_lshlrev_b32 v244, 16, v196
    v_and_b32 v248, 0xffff0000, v196
    v_lshlrev_b32 v245, 16, v197
    v_and_b32 v249, 0xffff0000, v197
    v_lshlrev_b32 v246, 16, v198
    v_and_b32 v250, 0xffff0000, v198
    v_lshlrev_b32 v247, 16, v199
    v_and_b32 v251, 0xffff0000, v199
    v_pk_fma_f32 v[144:145], v[244:245], s[30:31], v[144:145]
    v_pk_fma_f32 v[146:147], v[246:247], s[30:31], v[146:147]
    v_pk_fma_f32 v[148:149], v[248:249], s[30:31], v[148:149]
    v_pk_fma_f32 v[150:151], v[250:251], s[30:31], v[150:151]
    v_lshlrev_b32 v244, 16, v236
    v_and_b32 v245, 0xffff0000, v236
    v_lshlrev_b32 v246, 16, v237
    v_and_b32 v247, 0xffff0000, v237
    v_lshlrev_b32 v248, 16, v238
    v_and_b32 v249, 0xffff0000, v238
    v_lshlrev_b32 v250, 16, v239
    v_and_b32 v251, 0xffff0000, v239
    v_pk_add_f32 v[144:145], v[144:145], v[152:153]
    v_pk_add_f32 v[146:147], v[146:147], v[154:155]
    v_pk_add_f32 v[148:149], v[148:149], v[156:157]
    v_pk_add_f32 v[150:151], v[150:151], v[158:159]
    ds_read_b128 v[152:155], v7 offset:14384
    ds_read_b128 v[156:159], v7 offset:14400
    v_pk_add_f32 v[144:145], v[144:145], v[160:161]
    v_pk_add_f32 v[146:147], v[146:147], v[162:163]
    v_pk_add_f32 v[148:149], v[148:149], v[164:165]
    v_pk_add_f32 v[150:151], v[150:151], v[166:167]
    s_waitcnt lgkmcnt(15)
    v_pk_add_f32 v[144:145], v[144:145], v[168:169]
    v_pk_add_f32 v[146:147], v[146:147], v[170:171]
    v_pk_add_f32 v[148:149], v[148:149], v[172:173]
    v_pk_add_f32 v[150:151], v[150:151], v[174:175]
    ds_read_b128 v[160:163], v9 offset:6144
    ds_read_b128 v[164:167], v9 offset:6160
    ds_read_b128 v[168:171], v9 offset:14336
    ds_read_b128 v[172:175], v9 offset:14352
    s_waitcnt lgkmcnt(15)
    v_pk_fma_f32 v[176:177], v[244:245], v[176:177], v[184:185]
    v_pk_fma_f32 v[178:179], v[246:247], v[178:179], v[186:187]
    v_pk_fma_f32 v[180:181], v[248:249], v[180:181], v[188:189]
    v_pk_fma_f32 v[182:183], v[250:251], v[182:183], v[190:191]
    v_pk_fma_f32 v[176:177], v[176:177], v[144:145], v[244:245]
    v_pk_fma_f32 v[178:179], v[178:179], v[146:147], v[246:247]
    v_pk_fma_f32 v[180:181], v[180:181], v[148:149], v[248:249]
    v_pk_fma_f32 v[182:183], v[182:183], v[150:151], v[250:251]
    v_cvt_pk_bf16_f32 v184, v176, v177
    v_cvt_pk_bf16_f32 v185, v178, v179
    v_cvt_pk_bf16_f32 v186, v180, v181
    v_cvt_pk_bf16_f32 v187, v182, v183
    buffer_store_dwordx4 v[184:187], v2, s[4:7], s56 offen offset:2048 sc1
    s_waitcnt lgkmcnt(12)
    v_lshlrev_b32 v244, 16, v224
    v_and_b32 v248, 0xffff0000, v224
    v_lshlrev_b32 v245, 16, v225
    v_and_b32 v249, 0xffff0000, v225
    v_lshlrev_b32 v246, 16, v226
    v_and_b32 v250, 0xffff0000, v226
    v_lshlrev_b32 v247, 16, v227
    v_and_b32 v251, 0xffff0000, v227
    s_waitcnt lgkmcnt(10)
    v_pk_fma_f32 v[200:201], v[244:245], s[30:31], v[200:201]
    v_pk_fma_f32 v[202:203], v[246:247], s[30:31], v[202:203]
    v_pk_fma_f32 v[204:205], v[248:249], s[30:31], v[204:205]
    v_pk_fma_f32 v[206:207], v[250:251], s[30:31], v[206:207]
    v_lshlrev_b32 v244, 16, v240
    v_and_b32 v245, 0xffff0000, v240
    v_lshlrev_b32 v246, 16, v241
    v_and_b32 v247, 0xffff0000, v241
    v_lshlrev_b32 v248, 16, v242
    v_and_b32 v249, 0xffff0000, v242
    v_lshlrev_b32 v250, 16, v243
    v_and_b32 v251, 0xffff0000, v243
    s_waitcnt lgkmcnt(8)
    v_pk_add_f32 v[200:201], v[200:201], v[208:209]
    v_pk_add_f32 v[202:203], v[202:203], v[210:211]
    v_pk_add_f32 v[204:205], v[204:205], v[212:213]
    v_pk_add_f32 v[206:207], v[206:207], v[214:215]
    s_waitcnt lgkmcnt(6)
    v_pk_add_f32 v[200:201], v[200:201], v[216:217]
    v_pk_add_f32 v[202:203], v[202:203], v[218:219]
    v_pk_add_f32 v[204:205], v[204:205], v[220:221]
    v_pk_add_f32 v[206:207], v[206:207], v[222:223]
    s_waitcnt lgkmcnt(4)
    v_pk_add_f32 v[200:201], v[200:201], v[152:153]
    v_pk_add_f32 v[202:203], v[202:203], v[154:155]
    v_pk_add_f32 v[204:205], v[204:205], v[156:157]
    v_pk_add_f32 v[206:207], v[206:207], v[158:159]
    s_waitcnt lgkmcnt(0)
    v_pk_fma_f32 v[160:161], v[244:245], v[160:161], v[168:169]
    v_pk_fma_f32 v[162:163], v[246:247], v[162:163], v[170:171]
    v_pk_fma_f32 v[164:165], v[248:249], v[164:165], v[172:173]
    v_pk_fma_f32 v[166:167], v[250:251], v[166:167], v[174:175]
    v_pk_fma_f32 v[160:161], v[160:161], v[200:201], v[244:245]
    v_pk_fma_f32 v[162:163], v[162:163], v[202:203], v[246:247]
    v_pk_fma_f32 v[164:165], v[164:165], v[204:205], v[248:249]
    v_pk_fma_f32 v[166:167], v[166:167], v[206:207], v[250:251]
    v_cvt_pk_bf16_f32 v168, v160, v161
    v_cvt_pk_bf16_f32 v169, v162, v163
    v_cvt_pk_bf16_f32 v170, v164, v165
    v_cvt_pk_bf16_f32 v171, v166, v167
    buffer_store_dwordx4 v[168:171], v2, s[4:7], s56 offen offset:3072 sc1
    s_waitcnt vmcnt(2)
    s_branch gp_kernel_Lm
gp_kernel_L3:
    s_mov_b32 s59, 0x794000
    s_mov_b32 s96, 0
gp_kernel_pFE:
    s_add_u32 s96, s96, 1
    buffer_load_dword v244, v11, s[4:7], s59 offen sc1
    s_add_u32 s35, s59, 4096
    buffer_load_dword v245, v11, s[4:7], s35 offen sc1
    s_add_u32 s35, s59, 8192
    buffer_load_dword v246, v11, s[4:7], s35 offen sc1
    s_add_u32 s35, s59, 12288
    buffer_load_dword v247, v11, s[4:7], s35 offen sc1
    s_waitcnt vmcnt(0)
    v_xor_b32 v244, s28, v244
    v_xor_b32 v245, s28, v245
    v_xor_b32 v246, s28, v246
    v_xor_b32 v247, s28, v247
    v_or3_b32 v244, v244, v245, v246
    v_or_b32 v244, v244, v247
    v_cmp_ne_u32 vcc, 0, v244
    s_nop 4
    s_cbranch_vccz gp_kernel_Lm
    s_cmp_lt_u32 s96, 40000
    s_cbranch_scc1 gp_kernel_pFE
gp_kernel_Lm:
    s_mul_i32 s34, s3, 163840
    s_add_u32 s52, s52, s34
    s_add_u32 s53, s53, s34
    s_add_u32 s54, s54, s34
    s_add_u32 s55, s55, s34
    s_barrier
    s_add_u32 m0, s91, 0
    s_add_u32 s32, s52, 0
    buffer_load_dwordx4 v3, s[4:7], s32 offen sc1 lds
    s_add_u32 m0, s91, 1024
    s_add_u32 s32, s52, 32768
    buffer_load_dwordx4 v3, s[4:7], s32 offen sc1 lds
    s_add_u32 m0, s91, 2048
    s_add_u32 s32, s52, 65536
    buffer_load_dwordx4 v3, s[4:7], s32 offen sc1 lds
    s_add_u32 m0, s91, 3072
    s_add_u32 s32, s52, 98304
    buffer_load_dwordx4 v3, s[4:7], s32 offen sc1 lds
    s_add_u32 m0, s91, 4096
    s_add_u32 s32, s52, 131072
    buffer_load_dwordx4 v3, s[4:7], s32 offen sc1 lds
    v_mov_b32 v105, 0x3f803f80
    ds_read_b64_tr_b16 a[180:181], v252 offset:0
    ds_read_b64_tr_b16 a[182:183], v252 offset:3072
    ds_read_b64_tr_b16 a[184:185], v252 offset:6144
    ds_read_b64_tr_b16 a[186:187], v252 offset:9216
    ds_read_b64_tr_b16 a[188:189], v253 offset:0
    ds_read_b64_tr_b16 a[190:191], v253 offset:3072
    ds_read_b64_tr_b16 a[192:193], v252 offset:12288
    ds_read_b64_tr_b16 a[194:195], v252 offset:15360
    ds_read_b64_tr_b16 a[196:197], v252 offset:18432
    ds_read_b64_tr_b16 a[198:199], v252 offset:21504
    ds_read_b64_tr_b16 a[200:201], v253 offset:12288
    ds_read_b64_tr_b16 a[202:203], v253 offset:15360
    ds_read_b64_tr_b16 a[204:205], v252 offset:24576
    ds_read_b64_tr_b16 a[206:207], v252 offset:27648
    ds_read_b64_tr_b16 a[208:209], v252 offset:30720
    v_accvgpr_write_b32 a240, v105
    v_accvgpr_write_b32 a241, v105
    v_accvgpr_write_b32 a242, v105
    v_accvgpr_write_b32 a243, v105
    ds_read_b64_tr_b16 a[210:211], v252 offset:33792
    ds_read_b64_tr_b16 a[212:213], v253 offset:24576
    ds_read_b64_tr_b16 a[214:215], v253 offset:27648
    ds_read_b64_tr_b16 a[216:217], v252 offset:36864
    ds_read_b64_tr_b16 a[218:219], v252 offset:39936
    ds_read_b64_tr_b16 a[220:221], v252 offset:43008
    ds_read_b64_tr_b16 a[222:223], v252 offset:46080
    ds_read_b64_tr_b16 a[224:225], v253 offset:36864
    ds_read_b64_tr_b16 a[226:227], v253 offset:39936
    v_add_u32 v252, 49152, v252
    v_add_u32 v253, 49152, v253
    ds_read_b64_tr_b16 a[228:229], v252 offset:0
    ds_read_b64_tr_b16 a[230:231], v252 offset:3072
    ds_read_b64_tr_b16 a[232:233], v252 offset:6144
    ds_read_b64_tr_b16 a[234:235], v252 offset:9216
    ds_read_b64_tr_b16 a[236:237], v253 offset:0
    ds_read_b64_tr_b16 a[238:239], v253 offset:3072
    v_add_u32 v252, -49152, v252
    v_add_u32 v253, -49152, v253
    v_mfma_f32_16x16x32_bf16 a[244:247], a[36:39], a[240:243], a[244:247]
    v_lshrrev_b32 v100, 4, v1
    v_bfe_u32 v101, v1, 2, 2
    v_mfma_f32_16x16x32_bf16 a[248:251], a[40:43], a[240:243], a[248:251]
    v_and_b32 v102, 3, v1
    v_lshrrev_b32 v103, 1, v101
    v_mfma_f32_16x16x32_bf16 a[252:255], a[44:47], a[240:243], a[252:255]
    v_lshl_add_u32 v103, v100, 1, v103
    v_and_b32 v103, 3, v103
    v_mfma_f32_16x16x32_bf16 a[244:247], a[48:51], a[240:243], a[244:247]
    s_add_u32 m0, s91, 20480
    s_add_u32 s32, s53, 0
    buffer_load_dwordx4 v3, s[4:7], s32 offen sc1 lds
    v_lshl_add_u32 v104, v100, 2, v101
    v_lshlrev_b32 v104, 7, v104
    v_mfma_f32_16x16x32_bf16 a[248:251], a[52:55], a[240:243], a[248:251]
    v_lshl_add_u32 v104, v102, 3, v104
    v_add_u32 v104, 0, v104
    v_mfma_f32_16x16x32_bf16 a[252:255], a[56:59], a[240:243], a[252:255]
    v_xor_b32 v105, s3, v103
    v_lshl_add_u32 v4, v105, 5, v104
    v_mfma_f32_16x16x32_bf16 a[244:247], a[60:63], a[240:243], a[244:247]
    s_add_u32 m0, s91, 21504
    s_add_u32 s32, s53, 32768
    buffer_load_dwordx4 v3, s[4:7], s32 offen sc1 lds
    s_add_u32 s34, s3, 1
    s_and_b32 s34, s34, 3
    v_mfma_f32_16x16x32_bf16 a[248:251], a[64:67], a[240:243], a[248:251]
    v_xor_b32 v105, s34, v103
    v_lshl_add_u32 v5, v105, 5, v104
    v_mfma_f32_16x16x32_bf16 a[252:255], a[68:71], a[240:243], a[252:255]
    s_add_u32 s34, s3, 2
    s_and_b32 s34, s34, 3
    v_mfma_f32_16x16x32_bf16 a[244:247], a[72:75], a[240:243], a[244:247]
    v_xor_b32 v105, s34, v103
    v_lshl_add_u32 v6, v105, 5, v104
    v_mfma_f32_16x16x32_bf16 a[248:251], a[76:79], a[240:243], a[248:251]
    s_add_u32 m0, s91, 22528
    s_add_u32 s32, s53, 65536
    buffer_load_dwordx4 v3, s[4:7], s32 offen sc1 lds
    s_add_u32 s34, s3, 3
    s_and_b32 s34, s34, 3
    v_mfma_f32_16x16x32_bf16 a[252:255], a[80:83], a[240:243], a[252:255]
    v_xor_b32 v105, s34, v103
    v_lshl_add_u32 v7, v105, 5, v104
    v_mfma_f32_16x16x32_bf16 a[244:247], a[84:87], a[240:243], a[244:247]
    v_mad_u32_u24 v105, v100, 20, v101
    v_lshl_add_u32 v106, v102, 3, s22
    v_mfma_f32_16x16x32_bf16 a[248:251], a[88:91], a[240:243], a[248:251]
    s_add_u32 m0, s91, 23552
    s_add_u32 s32, s53, 98304
    buffer_load_dwordx4 v3, s[4:7], s32 offen sc1 lds
    v_lshl_add_u32 v105, v105, 7, v106
    v_xor_b32 v106, s23, v103
    v_mfma_f32_16x16x32_bf16 a[252:255], a[92:95], a[240:243], a[252:255]
    v_lshl_add_u32 v12, v106, 5, v105
    v_xor_b32 v13, 64, v12
    v_mfma_f32_16x16x32_bf16 a[244:247], a[96:99], a[240:243], a[244:247]
    v_and_b32 v105, 15, v1
    v_lshlrev_b32 v122, 6, v105
    v_mfma_f32_16x16x32_bf16 a[248:251], a[100:103], a[240:243], a[248:251]
    s_add_u32 m0, s91, 24576
    s_add_u32 s32, s53, 131072
    buffer_load_dwordx4 v3, s[4:7], s32 offen sc1 lds
    v_mul_u32_u24 v123, 1280, v105
    v_mad_u32_u24 v123, v100, 40, v123
    v_mfma_f32_16x16x32_bf16 a[252:255], a[104:107], a[240:243], a[252:255]
    v_lshl_add_u32 v14, v105, 3, s90
    v_lshlrev_b32 v105, 4, v105
    v_mfma_f32_16x16x32_bf16 a[244:247], a[108:111], a[240:243], a[244:247]
    v_and_b32 v106, 1, v100
    v_lshrrev_b32 v107, 1, v100
    v_mfma_f32_16x16x32_bf16 a[248:251], a[112:115], a[240:243], a[248:251]
    v_lshl_add_u32 v108, v107, 8, v105
    s_mov_b32 s34, 49152
    v_mfma_f32_16x16x32_bf16 a[252:255], a[116:119], a[240:243], a[252:255]
    s_add_u32 m0, s91, 40960
    s_add_u32 s32, s54, 0
    buffer_load_dwordx4 v3, s[4:7], s32 offen sc1 lds
    v_add_u32 v109, s3, v106
    v_and_b32 v109, 3, v109
    v_mfma_f32_16x16x32_bf16 a[244:247], a[120:123], a[240:243], a[244:247]
    v_mad_u32_u24 v8, v109, s34, v108
    v_xor_b32 v109, 2, v109
    v_mfma_f32_16x16x32_bf16 a[248:251], a[124:127], a[240:243], a[248:251]
    v_mad_u32_u24 v9, v109, s34, v108
    v_lshl_add_u32 v109, v106, 1, v107
    v_mfma_f32_16x16x32_bf16 a[252:255], a[128:131], a[240:243], a[252:255]
    s_add_u32 m0, s91, 41984
    s_add_u32 s32, s54, 32768
    buffer_load_dwordx4 v3, s[4:7], s32 offen sc1 lds
    v_add_u32 v109, s3, v109
    v_and_b32 v109, 3, v109
    v_mfma_f32_16x16x32_bf16 a[244:247], a[132:135], a[240:243], a[244:247]
    v_mad_u32_u24 v10, v109, s34, v105
    s_mov_b32 s82, -1
    v_mfma_f32_16x16x32_bf16 a[248:251], a[136:139], a[240:243], a[248:251]
    s_mov_b32 s80, 0xaaaaaaaa
    s_mov_b32 s81, 0xaaaaaaaa
    v_mfma_f32_16x16x32_bf16 a[252:255], a[140:143], a[240:243], a[252:255]
    s_mov_b32 s60, 0xcccccccc
    s_mov_b32 s61, 0xcccccccc
    v_mfma_f32_16x16x32_bf16 a[244:247], a[144:147], a[240:243], a[244:247]
    s_add_u32 m0, s91, 43008
    s_add_u32 s32, s54, 65536
    buffer_load_dwordx4 v3, s[4:7], s32 offen sc1 lds
    s_mov_b32 s62, 0x00f0000f
    s_mov_b32 s63, 0xf0000f00
    v_mfma_f32_16x16x32_bf16 a[248:251], a[148:151], a[240:243], a[248:251]
    v_mfma_f32_16x16x32_bf16 a[252:255], a[152:155], a[240:243], a[252:255]
    v_mfma_f32_16x16x32_bf16 a[244:247], a[156:159], a[240:243], a[244:247]
    s_add_u32 m0, s91, 44032
    s_add_u32 s32, s54, 98304
    buffer_load_dwordx4 v3, s[4:7], s32 offen sc1 lds
    v_mfma_f32_16x16x32_bf16 a[248:251], a[160:163], a[240:243], a[248:251]
    v_mfma_f32_16x16x32_bf16 a[252:255], a[164:167], a[240:243], a[252:255]
    v_mfma_f32_16x16x32_bf16 a[244:247], a[168:171], a[240:243], a[244:247]
    s_add_u32 m0, s91, 45056
    s_add_u32 s32, s54, 131072
    buffer_load_dwordx4 v3, s[4:7], s32 offen sc1 lds
    v_mfma_f32_16x16x32_bf16 a[248:251], a[172:175], a[240:243], a[248:251]
    v_mfma_f32_16x16x32_bf16 a[252:255], a[176:179], a[240:243], a[252:255]
    s_waitcnt lgkmcnt(15)
    v_mfma_f32_16x16x32_bf16 a[244:247], a[180:183], a[240:243], a[244:247]
    v_mfma_f32_16x16x32_bf16 a[248:251], a[184:187], a[240:243], a[248:251]
    s_add_u32 m0, s91, 61440
    s_add_u32 s32, s55, 0
    buffer_load_dwordx4 v3, s[4:7], s32 offen sc1 lds
    v_mfma_f32_16x16x32_bf16 a[252:255], a[188:191], a[240:243], a[252:255]
    v_mfma_f32_16x16x32_bf16 a[244:247], a[192:195], a[240:243], a[244:247]
    v_mfma_f32_16x16x32_bf16 a[248:251], a[196:199], a[240:243], a[248:251]
    s_add_u32 m0, s91, 62464
    s_add_u32 s32, s55, 32768
    buffer_load_dwordx4 v3, s[4:7], s32 offen sc1 lds
    v_mfma_f32_16x16x32_bf16 a[252:255], a[200:203], a[240:243], a[252:255]
    v_mfma_f32_16x16x32_bf16 a[244:247], a[204:207], a[240:243], a[244:247]
    s_waitcnt lgkmcnt(14)
    v_mfma_f32_16x16x32_bf16 a[248:251], a[208:211], a[240:243], a[248:251]
    s_waitcnt lgkmcnt(12)
    v_mfma_f32_16x16x32_bf16 a[252:255], a[212:215], a[240:243], a[252:255]
    s_add_u32 m0, s91, 63488
    s_add_u32 s32, s55, 65536
    buffer_load_dwordx4 v3, s[4:7], s32 offen sc1 lds
    s_waitcnt lgkmcnt(10)
    v_mfma_f32_16x16x32_bf16 a[244:247], a[216:219], a[240:243], a[244:247]
    s_waitcnt lgkmcnt(8)
    v_mfma_f32_16x16x32_bf16 a[248:251], a[220:223], a[240:243], a[248:251]
    s_waitcnt lgkmcnt(6)
    v_mfma_f32_16x16x32_bf16 a[252:255], a[224:227], a[240:243], a[252:255]
    s_add_u32 m0, s91, 64512
    s_add_u32 s32, s55, 98304
    buffer_load_dwordx4 v3, s[4:7], s32 offen sc1 lds
    s_waitcnt lgkmcnt(4)
    v_mfma_f32_16x16x32_bf16 a[244:247], a[228:231], a[240:243], a[244:247]
    s_waitcnt lgkmcnt(2)
    v_mfma_f32_16x16x32_bf16 a[248:251], a[232:235], a[240:243], a[248:251]
    s_waitcnt lgkmcnt(0)
    v_mfma_f32_16x16x32_bf16 a[252:255], a[236:239], a[240:243], a[252:255]
    s_add_u32 m0, s91, 65536
    s_add_u32 s32, s55, 131072
    buffer_load_dwordx4 v3, s[4:7], s32 offen sc1 lds
    s_nop 7
    s_nop 7
    v_accvgpr_read_b32 v244, a244
    v_accvgpr_read_b32 v245, a245
    v_accvgpr_read_b32 v246, a246
    v_accvgpr_read_b32 v247, a247
    v_accvgpr_read_b32 v248, a248
    v_accvgpr_read_b32 v249, a249
    v_accvgpr_read_b32 v250, a250
    v_accvgpr_read_b32 v251, a251
    v_accvgpr_read_b32 v252, a252
    v_accvgpr_read_b32 v253, a253
    v_accvgpr_read_b32 v254, a254
    v_accvgpr_read_b32 v255, a255
    s_waitcnt vmcnt(15)
    s_barrier
    s_mov_b64 exec, 1
    buffer_store_dword v0, v15, s[4:7], s39 offen sc1
    s_mov_b64 exec, -1
    ds_read_b64_tr_b16 v[16:17], v4 offset:0
    ds_read_b64_tr_b16 v[18:19], v4 offset:2048
    ds_read_b64_tr_b16 v[20:21], v5 offset:0
    ds_read_b64_tr_b16 v[22:23], v5 offset:2048
    ds_read_b64_tr_b16 v[24:25], v6 offset:0
    ds_read_b64_tr_b16 v[26:27], v6 offset:2048
    ds_read_b64_tr_b16 v[28:29], v7 offset:0
    ds_read_b64_tr_b16 v[30:31], v7 offset:2048
    s_waitcnt lgkmcnt(6)
    v_mfma_f32_16x16x32_bf16 v[48:51], a[0:3], v[16:19], 0
    ds_read_b64_tr_b16 v[32:33], v4 offset:4096
    v_mfma_f32_16x16x32_bf16 v[64:67], a[4:7], v[16:19], 0
    ds_read_b64_tr_b16 v[34:35], v4 offset:6144
    s_mov_b32 s90, s88
    buffer_load_dwordx4 v[124:127], v2, s[4:7], s90 offen offset:0 sc1
    v_mfma_f32_16x16x32_bf16 v[80:83], a[8:11], v[16:19], 0
    ds_read_b64_tr_b16 v[36:37], v5 offset:4096
    v_mfma_f32_16x16x32_bf16 v[96:99], v[16:19], v[16:19], 0
    s_waitcnt lgkmcnt(7)
    v_mfma_f32_16x16x32_bf16 v[52:55], a[0:3], v[20:23], 0
    ds_read_b64_tr_b16 v[38:39], v5 offset:6144
    buffer_load_dwordx4 v[128:131], v2, s[4:7], s90 offen offset:1024 sc1
    v_mfma_f32_16x16x32_bf16 v[68:71], a[4:7], v[20:23], 0
    ds_read_b64_tr_b16 v[40:41], v6 offset:4096
    v_mfma_f32_16x16x32_bf16 v[84:87], a[8:11], v[20:23], 0
    ds_read_b64_tr_b16 v[42:43], v6 offset:6144
    s_waitcnt lgkmcnt(8)
    v_mfma_f32_16x16x32_bf16 v[56:59], a[0:3], v[24:27], 0
    ds_read_b64_tr_b16 v[44:45], v7 offset:4096
    buffer_load_dwordx4 v[132:135], v2, s[4:7], s90 offen offset:2048 sc1
    v_mfma_f32_16x16x32_bf16 v[72:75], a[4:7], v[24:27], 0
    ds_read_b64_tr_b16 v[46:47], v7 offset:6144
    v_mfma_f32_16x16x32_bf16 v[88:91], a[8:11], v[24:27], 0
    v_mfma_f32_16x16x32_bf16 v[100:103], a[240:243], v[16:19], 0
    s_waitcnt lgkmcnt(8)
    v_mfma_f32_16x16x32_bf16 v[60:63], a[0:3], v[28:31], 0
    buffer_load_dwordx4 v[136:139], v2, s[4:7], s90 offen offset:3072 sc1
    v_mfma_f32_16x16x32_bf16 v[76:79], a[4:7], v[28:31], 0
    v_mfma_f32_16x16x32_bf16 v[92:95], a[8:11], v[28:31], 0
    s_waitcnt lgkmcnt(6)
    v_mfma_f32_16x16x32_bf16 v[48:51], a[12:15], v[32:35], v[48:51]
    ds_read_b64_tr_b16 v[16:17], v4 offset:8192
    v_mfma_f32_16x16x32_bf16 v[64:67], a[16:19], v[32:35], v[64:67]
    ds_read_b64_tr_b16 v[18:19], v4 offset:10240
    s_add_u32 s90, s90, 4096
    buffer_load_dwordx4 v[140:143], v2, s[4:7], s90 offen offset:0 sc1
    v_mfma_f32_16x16x32_bf16 v[80:83], a[20:23], v[32:35], v[80:83]
    ds_read_b64_tr_b16 v[20:21], v5 offset:8192
    v_mfma_f32_16x16x32_bf16 v[96:99], v[32:35], v[32:35], v[96:99]
    s_waitcnt lgkmcnt(7)
    v_mfma_f32_16x16x32_bf16 v[52:55], a[12:15], v[36:39], v[52:55]
    ds_read_b64_tr_b16 v[22:23], v5 offset:10240
    buffer_load_dwordx4 v[144:147], v2, s[4:7], s90 offen offset:1024 sc1
    v_mfma_f32_16x16x32_bf16 v[68:71], a[16:19], v[36:39], v[68:71]
    ds_read_b64_tr_b16 v[24:25], v6 offset:8192
    v_mfma_f32_16x16x32_bf16 v[84:87], a[20:23], v[36:39], v[84:87]
    ds_read_b64_tr_b16 v[26:27], v6 offset:10240
    s_waitcnt lgkmcnt(8)
    v_mfma_f32_16x16x32_bf16 v[56:59], a[12:15], v[40:43], v[56:59]
    ds_read_b64_tr_b16 v[28:29], v7 offset:8192
    buffer_load_dwordx4 v[148:151], v2, s[4:7], s90 offen offset:2048 sc1
    v_mfma_f32_16x16x32_bf16 v[72:75], a[16:19], v[40:43], v[72:75]
    ds_read_b64_tr_b16 v[30:31], v7 offset:10240
    v_mfma_f32_16x16x32_bf16 v[88:91], a[20:23], v[40:43], v[88:91]
    v_mfma_f32_16x16x32_bf16 v[100:103], a[240:243], v[32:35], v[100:103]
    s_waitcnt lgkmcnt(8)
    v_mfma_f32_16x16x32_bf16 v[60:63], a[12:15], v[44:47], v[60:63]
    buffer_load_dwordx4 v[152:155], v2, s[4:7], s90 offen offset:3072 sc1
    v_mfma_f32_16x16x32_bf16 v[76:79], a[16:19], v[44:47], v[76:79]
    v_mfma_f32_16x16x32_bf16 v[92:95], a[20:23], v[44:47], v[92:95]
    s_waitcnt lgkmcnt(6)
    v_mfma_f32_16x16x32_bf16 v[48:51], a[24:27], v[16:19], v[48:51]
    ds_read_b64_tr_b16 v[32:33], v4 offset:12288
    v_mfma_f32_16x16x32_bf16 v[64:67], a[28:31], v[16:19], v[64:67]
    ds_read_b64_tr_b16 v[34:35], v4 offset:14336
    s_add_u32 s90, s90, 4096
    buffer_load_dwordx4 v[156:159], v2, s[4:7], s90 offen offset:0 sc1
    v_mfma_f32_16x16x32_bf16 v[80:83], a[32:35], v[16:19], v[80:83]
    ds_read_b64_tr_b16 v[36:37], v5 offset:12288
    v_mfma_f32_16x16x32_bf16 v[96:99], v[16:19], v[16:19], v[96:99]
    s_waitcnt lgkmcnt(7)
    v_mfma_f32_16x16x32_bf16 v[52:55], a[24:27], v[20:23], v[52:55]
    ds_read_b64_tr_b16 v[38:39], v5 offset:14336
    buffer_load_dwordx4 v[160:163], v2, s[4:7], s90 offen offset:1024 sc1
    v_mfma_f32_16x16x32_bf16 v[68:71], a[28:31], v[20:23], v[68:71]
    ds_read_b64_tr_b16 v[40:41], v6 offset:12288
    v_mfma_f32_16x16x32_bf16 v[84:87], a[32:35], v[20:23], v[84:87]
    ds_read_b64_tr_b16 v[42:43], v6 offset:14336
    s_waitcnt lgkmcnt(8)
    v_mfma_f32_16x16x32_bf16 v[56:59], a[24:27], v[24:27], v[56:59]
    ds_read_b64_tr_b16 v[44:45], v7 offset:12288
    buffer_load_dwordx4 v[164:167], v2, s[4:7], s90 offen offset:2048 sc1
    v_mfma_f32_16x16x32_bf16 v[72:75], a[28:31], v[24:27], v[72:75]
    ds_read_b64_tr_b16 v[46:47], v7 offset:14336
    v_mfma_f32_16x16x32_bf16 v[88:91], a[32:35], v[24:27], v[88:91]
    v_mfma_f32_16x16x32_bf16 v[100:103], a[240:243], v[16:19], v[100:103]
    s_waitcnt lgkmcnt(8)
    v_mfma_f32_16x16x32_bf16 v[60:63], a[24:27], v[28:31], v[60:63]
    buffer_load_dwordx4 v[168:171], v2, s[4:7], s90 offen offset:3072 sc1
    v_mfma_f32_16x16x32_bf16 v[76:79], a[28:31], v[28:31], v[76:79]
    v_mfma_f32_16x16x32_bf16 v[92:95], a[32:35], v[28:31], v[92:95]
    s_waitcnt lgkmcnt(6)
    v_mfma_f32_16x16x32_bf16 v[48:51], a[36:39], v[32:35], v[48:51]
    ds_read_b64_tr_b16 v[16:17], v4 offset:16384
    v_mfma_f32_16x16x32_bf16 v[64:67], a[40:43], v[32:35], v[64:67]
    ds_read_b64_tr_b16 v[18:19], v4 offset:18432
    s_add_u32 s90, s90, 4096
    buffer_load_dwordx4 v[172:175], v2, s[4:7], s90 offen offset:0 sc1
    v_mfma_f32_16x16x32_bf16 v[80:83], a[44:47], v[32:35], v[80:83]
    ds_read_b64_tr_b16 v[20:21], v5 offset:16384
    v_mfma_f32_16x16x32_bf16 v[96:99], v[32:35], v[32:35], v[96:99]
    s_waitcnt lgkmcnt(7)
    v_mfma_f32_16x16x32_bf16 v[52:55], a[36:39], v[36:39], v[52:55]
    ds_read_b64_tr_b16 v[22:23], v5 offset:18432
    buffer_load_dwordx4 v[176:179], v2, s[4:7], s90 offen offset:1024 sc1
    v_mfma_f32_16x16x32_bf16 v[68:71], a[40:43], v[36:39], v[68:71]
    ds_read_b64_tr_b16 v[24:25], v6 offset:16384
    v_mfma_f32_16x16x32_bf16 v[84:87], a[44:47], v[36:39], v[84:87]
    ds_read_b64_tr_b16 v[26:27], v6 offset:18432
    s_waitcnt lgkmcnt(8)
    v_mfma_f32_16x16x32_bf16 v[56:59], a[36:39], v[40:43], v[56:59]
    ds_read_b64_tr_b16 v[28:29], v7 offset:16384
    buffer_load_dwordx4 v[180:183], v2, s[4:7], s90 offen offset:2048 sc1
    v_mfma_f32_16x16x32_bf16 v[72:75], a[40:43], v[40:43], v[72:75]
    ds_read_b64_tr_b16 v[30:31], v7 offset:18432
    v_mfma_f32_16x16x32_bf16 v[88:91], a[44:47], v[40:43], v[88:91]
    v_mfma_f32_16x16x32_bf16 v[100:103], a[240:243], v[32:35], v[100:103]
    s_waitcnt lgkmcnt(8)
    v_mfma_f32_16x16x32_bf16 v[60:63], a[36:39], v[44:47], v[60:63]
    buffer_load_dwordx4 v[184:187], v2, s[4:7], s90 offen offset:3072 sc1
    v_mfma_f32_16x16x32_bf16 v[76:79], a[40:43], v[44:47], v[76:79]
    v_mfma_f32_16x16x32_bf16 v[92:95], a[44:47], v[44:47], v[92:95]
    s_waitcnt vmcnt(27)
    s_barrier
    s_waitcnt lgkmcnt(6)
    v_mfma_f32_16x16x32_bf16 v[48:51], a[48:51], v[16:19], v[48:51]
    ds_read_b64_tr_b16 v[32:33], v4 offset:20480
    v_mfma_f32_16x16x32_bf16 v[64:67], a[52:55], v[16:19], v[64:67]
    ds_read_b64_tr_b16 v[34:35], v4 offset:22528
    s_add_u32 s90, s90, 4096
    buffer_load_dwordx4 v[188:191], v2, s[4:7], s90 offen offset:0 sc1
    v_mfma_f32_16x16x32_bf16 v[80:83], a[56:59], v[16:19], v[80:83]
    ds_read_b64_tr_b16 v[36:37], v5 offset:20480
    v_mfma_f32_16x16x32_bf16 v[96:99], v[16:19], v[16:19], v[96:99]
    s_waitcnt lgkmcnt(7)
    v_mfma_f32_16x16x32_bf16 v[52:55], a[48:51], v[20:23], v[52:55]
    ds_read_b64_tr_b16 v[38:39], v5 offset:22528
    buffer_load_dwordx4 v[192:195], v2, s[4:7], s90 offen offset:1024 sc1
    v_mfma_f32_16x16x32_bf16 v[68:71], a[52:55], v[20:23], v[68:71]
    ds_read_b64_tr_b16 v[40:41], v6 offset:20480
    v_mfma_f32_16x16x32_bf16 v[84:87], a[56:59], v[20:23], v[84:87]
    ds_read_b64_tr_b16 v[42:43], v6 offset:22528
    s_waitcnt lgkmcnt(8)
    v_mfma_f32_16x16x32_bf16 v[56:59], a[48:51], v[24:27], v[56:59]
    ds_read_b64_tr_b16 v[44:45], v7 offset:20480
    buffer_load_dwordx4 v[196:199], v2, s[4:7], s90 offen offset:2048 sc1
    v_mfma_f32_16x16x32_bf16 v[72:75], a[52:55], v[24:27], v[72:75]
    ds_read_b64_tr_b16 v[46:47], v7 offset:22528
    v_mfma_f32_16x16x32_bf16 v[88:91], a[56:59], v[24:27], v[88:91]
    v_mfma_f32_16x16x32_bf16 v[100:103], a[240:243], v[16:19], v[100:103]
    s_waitcnt lgkmcnt(8)
    v_mfma_f32_16x16x32_bf16 v[60:63], a[48:51], v[28:31], v[60:63]
    buffer_load_dwordx4 v[200:203], v2, s[4:7], s90 offen offset:3072 sc1
    v_mfma_f32_16x16x32_bf16 v[76:79], a[52:55], v[28:31], v[76:79]
    v_mfma_f32_16x16x32_bf16 v[92:95], a[56:59], v[28:31], v[92:95]
    s_waitcnt lgkmcnt(6)
    v_mfma_f32_16x16x32_bf16 v[48:51], a[60:63], v[32:35], v[48:51]
    ds_read_b64_tr_b16 v[16:17], v4 offset:24576
    v_mfma_f32_16x16x32_bf16 v[64:67], a[64:67], v[32:35], v[64:67]
    ds_read_b64_tr_b16 v[18:19], v4 offset:26624
    s_add_u32 s90, s90, 4096
    buffer_load_dwordx4 v[204:207], v2, s[4:7], s90 offen offset:0 sc1
    v_mfma_f32_16x16x32_bf16 v[80:83], a[68:71], v[32:35], v[80:83]
    ds_read_b64_tr_b16 v[20:21], v5 offset:24576
    v_mfma_f32_16x16x32_bf16 v[96:99], v[32:35], v[32:35], v[96:99]
    s_waitcnt lgkmcnt(7)
    v_mfma_f32_16x16x32_bf16 v[52:55], a[60:63], v[36:39], v[52:55]
    ds_read_b64_tr_b16 v[22:23], v5 offset:26624
    buffer_load_dwordx4 v[208:211], v2, s[4:7], s90 offen offset:1024 sc1
    v_mfma_f32_16x16x32_bf16 v[68:71], a[64:67], v[36:39], v[68:71]
    ds_read_b64_tr_b16 v[24:25], v6 offset:24576
    v_mfma_f32_16x16x32_bf16 v[84:87], a[68:71], v[36:39], v[84:87]
    ds_read_b64_tr_b16 v[26:27], v6 offset:26624
    s_waitcnt lgkmcnt(8)
    v_mfma_f32_16x16x32_bf16 v[56:59], a[60:63], v[40:43], v[56:59]
    ds_read_b64_tr_b16 v[28:29], v7 offset:24576
    buffer_load_dwordx4 v[212:215], v2, s[4:7], s90 offen offset:2048 sc1
    v_mfma_f32_16x16x32_bf16 v[72:75], a[64:67], v[40:43], v[72:75]
    ds_read_b64_tr_b16 v[30:31], v7 offset:26624
    v_mfma_f32_16x16x32_bf16 v[88:91], a[68:71], v[40:43], v[88:91]
    v_mfma_f32_16x16x32_bf16 v[100:103], a[240:243], v[32:35], v[100:103]
    s_waitcnt lgkmcnt(8)
    v_mfma_f32_16x16x32_bf16 v[60:63], a[60:63], v[44:47], v[60:63]
    buffer_load_dwordx4 v[216:219], v2, s[4:7], s90 offen offset:3072 sc1
    v_mfma_f32_16x16x32_bf16 v[76:79], a[64:67], v[44:47], v[76:79]
    v_mfma_f32_16x16x32_bf16 v[92:95], a[68:71], v[44:47], v[92:95]
    s_waitcnt lgkmcnt(6)
    v_mfma_f32_16x16x32_bf16 v[48:51], a[72:75], v[16:19], v[48:51]
    ds_read_b64_tr_b16 v[32:33], v4 offset:28672
    v_mfma_f32_16x16x32_bf16 v[64:67], a[76:79], v[16:19], v[64:67]
    ds_read_b64_tr_b16 v[34:35], v4 offset:30720
    s_add_u32 s90, s90, 4096
    buffer_load_dwordx4 v[220:223], v2, s[4:7], s90 offen offset:0 sc1
    v_mfma_f32_16x16x32_bf16 v[80:83], a[80:83], v[16:19], v[80:83]
    ds_read_b64_tr_b16 v[36:37], v5 offset:28672
    v_mfma_f32_16x16x32_bf16 v[96:99], v[16:19], v[16:19], v[96:99]
    s_waitcnt lgkmcnt(7)
    v_mfma_f32_16x16x32_bf16 v[52:55], a[72:75], v[20:23], v[52:55]
    ds_read_b64_tr_b16 v[38:39], v5 offset:30720
    buffer_load_dwordx4 v[224:227], v2, s[4:7], s90 offen offset:1024 sc1
    v_mfma_f32_16x16x32_bf16 v[68:71], a[76:79], v[20:23], v[68:71]
    ds_read_b64_tr_b16 v[40:41], v6 offset:28672
    v_mfma_f32_16x16x32_bf16 v[84:87], a[80:83], v[20:23], v[84:87]
    ds_read_b64_tr_b16 v[42:43], v6 offset:30720
    s_waitcnt lgkmcnt(8)
    v_mfma_f32_16x16x32_bf16 v[56:59], a[72:75], v[24:27], v[56:59]
    ds_read_b64_tr_b16 v[44:45], v7 offset:28672
    buffer_load_dwordx4 v[228:231], v2, s[4:7], s90 offen offset:2048 sc1
    v_mfma_f32_16x16x32_bf16 v[72:75], a[76:79], v[24:27], v[72:75]
    ds_read_b64_tr_b16 v[46:47], v7 offset:30720
    v_mfma_f32_16x16x32_bf16 v[88:91], a[80:83], v[24:27], v[88:91]
    v_mfma_f32_16x16x32_bf16 v[100:103], a[240:243], v[16:19], v[100:103]
    s_waitcnt lgkmcnt(8)
    v_mfma_f32_16x16x32_bf16 v[60:63], a[72:75], v[28:31], v[60:63]
    buffer_load_dwordx4 v[232:235], v2, s[4:7], s90 offen offset:3072 sc1
    v_mfma_f32_16x16x32_bf16 v[76:79], a[76:79], v[28:31], v[76:79]
    v_mfma_f32_16x16x32_bf16 v[92:95], a[80:83], v[28:31], v[92:95]
    s_waitcnt lgkmcnt(6)
    v_mfma_f32_16x16x32_bf16 v[48:51], a[84:87], v[32:35], v[48:51]
    ds_read_b64_tr_b16 v[16:17], v4 offset:32768
    v_mfma_f32_16x16x32_bf16 v[64:67], a[88:91], v[32:35], v[64:67]
    ds_read_b64_tr_b16 v[18:19], v4 offset:34816
    s_add_u32 s90, s90, 4096
    buffer_load_dwordx4 v[236:239], v2, s[4:7], s90 offen offset:0 sc1
    v_mfma_f32_16x16x32_bf16 v[80:83], a[92:95], v[32:35], v[80:83]
    ds_read_b64_tr_b16 v[20:21], v5 offset:32768
    v_mfma_f32_16x16x32_bf16 v[96:99], v[32:35], v[32:35], v[96:99]
    s_waitcnt lgkmcnt(7)
    v_mfma_f32_16x16x32_bf16 v[52:55], a[84:87], v[36:39], v[52:55]
    ds_read_b64_tr_b16 v[22:23], v5 offset:34816
    v_mfma_f32_16x16x32_bf16 v[68:71], a[88:91], v[36:39], v[68:71]
    ds_read_b64_tr_b16 v[24:25], v6 offset:32768
    v_mfma_f32_16x16x32_bf16 v[84:87], a[92:95], v[36:39], v[84:87]
    ds_read_b64_tr_b16 v[26:27], v6 offset:34816
    s_waitcnt lgkmcnt(8)
    v_mfma_f32_16x16x32_bf16 v[56:59], a[84:87], v[40:43], v[56:59]
    ds_read_b64_tr_b16 v[28:29], v7 offset:32768
    buffer_load_dwordx4 v[240:243], v2, s[4:7], s90 offen offset:1024 sc1
    v_mfma_f32_16x16x32_bf16 v[72:75], a[88:91], v[40:43], v[72:75]
    ds_read_b64_tr_b16 v[30:31], v7 offset:34816
    v_mfma_f32_16x16x32_bf16 v[88:91], a[92:95], v[40:43], v[88:91]
    v_mfma_f32_16x16x32_bf16 v[100:103], a[240:243], v[32:35], v[100:103]
    s_waitcnt lgkmcnt(8)
    v_mfma_f32_16x16x32_bf16 v[60:63], a[84:87], v[44:47], v[60:63]
    v_mfma_f32_16x16x32_bf16 v[76:79], a[88:91], v[44:47], v[76:79]
    v_mfma_f32_16x16x32_bf16 v[92:95], a[92:95], v[44:47], v[92:95]
    s_waitcnt lgkmcnt(6)
    v_mfma_f32_16x16x32_bf16 v[48:51], a[96:99], v[16:19], v[48:51]
    ds_read_b64_tr_b16 v[32:33], v4 offset:36864
    v_mfma_f32_16x16x32_bf16 v[64:67], a[100:103], v[16:19], v[64:67]
    ds_read_b64_tr_b16 v[34:35], v4 offset:38912
    v_mfma_f32_16x16x32_bf16 v[80:83], a[104:107], v[16:19], v[80:83]
    ds_read_b64_tr_b16 v[36:37], v5 offset:36864
    v_mfma_f32_16x16x32_bf16 v[96:99], v[16:19], v[16:19], v[96:99]
    s_waitcnt lgkmcnt(7)
    v_mfma_f32_16x16x32_bf16 v[52:55], a[96:99], v[20:23], v[52:55]
    ds_read_b64_tr_b16 v[38:39], v5 offset:38912
    v_mfma_f32_16x16x32_bf16 v[68:71], a[100:103], v[20:23], v[68:71]
    ds_read_b64_tr_b16 v[40:41], v6 offset:36864
    v_mfma_f32_16x16x32_bf16 v[84:87], a[104:107], v[20:23], v[84:87]
    ds_read_b64_tr_b16 v[42:43], v6 offset:38912
    s_waitcnt lgkmcnt(8)
    v_mfma_f32_16x16x32_bf16 v[56:59], a[96:99], v[24:27], v[56:59]
    ds_read_b64_tr_b16 v[44:45], v7 offset:36864
    v_mfma_f32_16x16x32_bf16 v[72:75], a[100:103], v[24:27], v[72:75]
    ds_read_b64_tr_b16 v[46:47], v7 offset:38912
    v_mfma_f32_16x16x32_bf16 v[88:91], a[104:107], v[24:27], v[88:91]
    v_mfma_f32_16x16x32_bf16 v[100:103], a[240:243], v[16:19], v[100:103]
    s_waitcnt lgkmcnt(8)
    v_mfma_f32_16x16x32_bf16 v[60:63], a[96:99], v[28:31], v[60:63]
    v_mfma_f32_16x16x32_bf16 v[76:79], a[100:103], v[28:31], v[76:79]
    v_mfma_f32_16x16x32_bf16 v[92:95], a[104:107], v[28:31], v[92:95]
    s_waitcnt vmcnt(36)
    s_barrier
    s_waitcnt lgkmcnt(6)
    v_mfma_f32_16x16x32_bf16 v[48:51], a[108:111], v[32:35], v[48:51]
    ds_read_b64_tr_b16 v[16:17], v4 offset:40960
    v_mfma_f32_16x16x32_bf16 v[64:67], a[112:115], v[32:35], v[64:67]
    ds_read_b64_tr_b16 v[18:19], v4 offset:43008
    v_mfma_f32_16x16x32_bf16 v[80:83], a[116:119], v[32:35], v[80:83]
    ds_read_b64_tr_b16 v[20:21], v5 offset:40960
    v_mfma_f32_16x16x32_bf16 v[96:99], v[32:35], v[32:35], v[96:99]
    s_waitcnt lgkmcnt(7)
    v_mfma_f32_16x16x32_bf16 v[52:55], a[108:111], v[36:39], v[52:55]
    ds_read_b64_tr_b16 v[22:23], v5 offset:43008
    v_mfma_f32_16x16x32_bf16 v[68:71], a[112:115], v[36:39], v[68:71]
    ds_read_b64_tr_b16 v[24:25], v6 offset:40960
    v_mfma_f32_16x16x32_bf16 v[84:87], a[116:119], v[36:39], v[84:87]
    ds_read_b64_tr_b16 v[26:27], v6 offset:43008
    s_waitcnt lgkmcnt(8)
    v_mfma_f32_16x16x32_bf16 v[56:59], a[108:111], v[40:43], v[56:59]
    ds_read_b64_tr_b16 v[28:29], v7 offset:40960
    v_mfma_f32_16x16x32_bf16 v[72:75], a[112:115], v[40:43], v[72:75]
    ds_read_b64_tr_b16 v[30:31], v7 offset:43008
    v_mfma_f32_16x16x32_bf16 v[88:91], a[116:119], v[40:43], v[88:91]
    v_mfma_f32_16x16x32_bf16 v[100:103], a[240:243], v[32:35], v[100:103]
    s_waitcnt lgkmcnt(8)
    v_mfma_f32_16x16x32_bf16 v[60:63], a[108:111], v[44:47], v[60:63]
    v_mfma_f32_16x16x32_bf16 v[76:79], a[112:115], v[44:47], v[76:79]
    v_mfma_f32_16x16x32_bf16 v[92:95], a[116:119], v[44:47], v[92:95]
    s_waitcnt lgkmcnt(6)
    v_mfma_f32_16x16x32_bf16 v[48:51], a[120:123], v[16:19], v[48:51]
    ds_read_b64_tr_b16 v[32:33], v4 offset:45056
    v_mfma_f32_16x16x32_bf16 v[64:67], a[124:127], v[16:19], v[64:67]
    ds_read_b64_tr_b16 v[34:35], v4 offset:47104
    v_mfma_f32_16x16x32_bf16 v[80:83], a[128:131], v[16:19], v[80:83]
    ds_read_b64_tr_b16 v[36:37], v5 offset:45056
    v_mfma_f32_16x16x32_bf16 v[96:99], v[16:19], v[16:19], v[96:99]
    s_waitcnt lgkmcnt(7)
    v_mfma_f32_16x16x32_bf16 v[52:55], a[120:123], v[20:23], v[52:55]
    ds_read_b64_tr_b16 v[38:39], v5 offset:47104
    v_mfma_f32_16x16x32_bf16 v[68:71], a[124:127], v[20:23], v[68:71]
    ds_read_b64_tr_b16 v[40:41], v6 offset:45056
    v_mfma_f32_16x16x32_bf16 v[84:87], a[128:131], v[20:23], v[84:87]
    ds_read_b64_tr_b16 v[42:43], v6 offset:47104
    s_waitcnt lgkmcnt(8)
    v_mfma_f32_16x16x32_bf16 v[56:59], a[120:123], v[24:27], v[56:59]
    ds_read_b64_tr_b16 v[44:45], v7 offset:45056
    v_mfma_f32_16x16x32_bf16 v[72:75], a[124:127], v[24:27], v[72:75]
    ds_read_b64_tr_b16 v[46:47], v7 offset:47104
    v_mfma_f32_16x16x32_bf16 v[88:91], a[128:131], v[24:27], v[88:91]
    v_mfma_f32_16x16x32_bf16 v[100:103], a[240:243], v[16:19], v[100:103]
    s_waitcnt lgkmcnt(8)
    v_mfma_f32_16x16x32_bf16 v[60:63], a[120:123], v[28:31], v[60:63]
    v_mfma_f32_16x16x32_bf16 v[76:79], a[124:127], v[28:31], v[76:79]
    v_mfma_f32_16x16x32_bf16 v[92:95], a[128:131], v[28:31], v[92:95]
    s_waitcnt lgkmcnt(6)
    v_mfma_f32_16x16x32_bf16 v[48:51], a[132:135], v[32:35], v[48:51]
    ds_read_b64_tr_b16 v[16:17], v4 offset:49152
    v_mfma_f32_16x16x32_bf16 v[64:67], a[136:139], v[32:35], v[64:67]
    ds_read_b64_tr_b16 v[18:19], v4 offset:51200
    v_mfma_f32_16x16x32_bf16 v[80:83], a[140:143], v[32:35], v[80:83]
    ds_read_b64_tr_b16 v[20:21], v5 offset:49152
    v_mfma_f32_16x16x32_bf16 v[96:99], v[32:35], v[32:35], v[96:99]
    s_waitcnt lgkmcnt(7)
    v_mfma_f32_16x16x32_bf16 v[52:55], a[132:135], v[36:39], v[52:55]
    ds_read_b64_tr_b16 v[22:23], v5 offset:51200
    v_mfma_f32_16x16x32_bf16 v[68:71], a[136:139], v[36:39], v[68:71]
    ds_read_b64_tr_b16 v[24:25], v6 offset:49152
    v_mfma_f32_16x16x32_bf16 v[84:87], a[140:143], v[36:39], v[84:87]
    ds_read_b64_tr_b16 v[26:27], v6 offset:51200
    s_waitcnt lgkmcnt(8)
    v_mfma_f32_16x16x32_bf16 v[56:59], a[132:135], v[40:43], v[56:59]
    ds_read_b64_tr_b16 v[28:29], v7 offset:49152
    v_mfma_f32_16x16x32_bf16 v[72:75], a[136:139], v[40:43], v[72:75]
    ds_read_b64_tr_b16 v[30:31], v7 offset:51200
    v_mfma_f32_16x16x32_bf16 v[88:91], a[140:143], v[40:43], v[88:91]
    v_mfma_f32_16x16x32_bf16 v[100:103], a[240:243], v[32:35], v[100:103]
    buffer_load_dword v119, v11, s[4:7], s87 offen sc1
    s_waitcnt lgkmcnt(8)
    v_mfma_f32_16x16x32_bf16 v[60:63], a[132:135], v[44:47], v[60:63]
    v_mfma_f32_16x16x32_bf16 v[76:79], a[136:139], v[44:47], v[76:79]
    v_mfma_f32_16x16x32_bf16 v[92:95], a[140:143], v[44:47], v[92:95]
    s_waitcnt lgkmcnt(6)
    v_mfma_f32_16x16x32_bf16 v[48:51], a[144:147], v[16:19], v[48:51]
    ds_read_b64_tr_b16 v[32:33], v4 offset:53248
    v_mfma_f32_16x16x32_bf16 v[64:67], a[148:151], v[16:19], v[64:67]
    ds_read_b64_tr_b16 v[34:35], v4 offset:55296
    v_mfma_f32_16x16x32_bf16 v[80:83], a[152:155], v[16:19], v[80:83]
    ds_read_b64_tr_b16 v[36:37], v5 offset:53248
    v_mfma_f32_16x16x32_bf16 v[96:99], v[16:19], v[16:19], v[96:99]
    s_waitcnt lgkmcnt(7)
    v_mfma_f32_16x16x32_bf16 v[52:55], a[144:147], v[20:23], v[52:55]
    ds_read_b64_tr_b16 v[38:39], v5 offset:55296
    v_mfma_f32_16x16x32_bf16 v[68:71], a[148:151], v[20:23], v[68:71]
    ds_read_b64_tr_b16 v[40:41], v6 offset:53248
    v_mfma_f32_16x16x32_bf16 v[84:87], a[152:155], v[20:23], v[84:87]
    ds_read_b64_tr_b16 v[42:43], v6 offset:55296
    s_waitcnt lgkmcnt(8)
    v_mfma_f32_16x16x32_bf16 v[56:59], a[144:147], v[24:27], v[56:59]
    ds_read_b64_tr_b16 v[44:45], v7 offset:53248
    v_mfma_f32_16x16x32_bf16 v[72:75], a[148:151], v[24:27], v[72:75]
    ds_read_b64_tr_b16 v[46:47], v7 offset:55296
    v_mfma_f32_16x16x32_bf16 v[88:91], a[152:155], v[24:27], v[88:91]
    v_mfma_f32_16x16x32_bf16 v[100:103], a[240:243], v[16:19], v[100:103]
    s_waitcnt lgkmcnt(8)
    v_mfma_f32_16x16x32_bf16 v[60:63], a[144:147], v[28:31], v[60:63]
    v_mfma_f32_16x16x32_bf16 v[76:79], a[148:151], v[28:31], v[76:79]
    v_mfma_f32_16x16x32_bf16 v[92:95], a[152:155], v[28:31], v[92:95]
    s_waitcnt lgkmcnt(6)
    v_mfma_f32_16x16x32_bf16 v[48:51], a[156:159], v[32:35], v[48:51]
    ds_read_b64_tr_b16 v[16:17], v4 offset:57344
    v_mfma_f32_16x16x32_bf16 v[64:67], a[160:163], v[32:35], v[64:67]
    ds_read_b64_tr_b16 v[18:19], v4 offset:59392
    v_mfma_f32_16x16x32_bf16 v[80:83], a[164:167], v[32:35], v[80:83]
    ds_read_b64_tr_b16 v[20:21], v5 offset:57344
    v_mfma_f32_16x16x32_bf16 v[96:99], v[32:35], v[32:35], v[96:99]
    s_waitcnt lgkmcnt(7)
    v_mfma_f32_16x16x32_bf16 v[52:55], a[156:159], v[36:39], v[52:55]
    ds_read_b64_tr_b16 v[22:23], v5 offset:59392
    v_mfma_f32_16x16x32_bf16 v[68:71], a[160:163], v[36:39], v[68:71]
    ds_read_b64_tr_b16 v[24:25], v6 offset:57344
    v_mfma_f32_16x16x32_bf16 v[84:87], a[164:167], v[36:39], v[84:87]
    ds_read_b64_tr_b16 v[26:27], v6 offset:59392
    s_waitcnt lgkmcnt(8)
    v_mfma_f32_16x16x32_bf16 v[56:59], a[156:159], v[40:43], v[56:59]
    ds_read_b64_tr_b16 v[28:29], v7 offset:57344
    v_mfma_f32_16x16x32_bf16 v[72:75], a[160:163], v[40:43], v[72:75]
    ds_read_b64_tr_b16 v[30:31], v7 offset:59392
    v_mfma_f32_16x16x32_bf16 v[88:91], a[164:167], v[40:43], v[88:91]
    v_mfma_f32_16x16x32_bf16 v[100:103], a[240:243], v[32:35], v[100:103]
    s_waitcnt vmcnt(0)
    v_cmp_ne_u32 vcc, s28, v119
    s_waitcnt lgkmcnt(8)
    v_mfma_f32_16x16x32_bf16 v[60:63], a[156:159], v[44:47], v[60:63]
    v_mfma_f32_16x16x32_bf16 v[76:79], a[160:163], v[44:47], v[76:79]
    v_mfma_f32_16x16x32_bf16 v[92:95], a[164:167], v[44:47], v[92:95]
    s_cbranch_vccnz gp_kernel_FLs
gp_kernel_FLd:
    s_barrier
    s_waitcnt lgkmcnt(6)
    v_mfma_f32_16x16x32_bf16 v[48:51], a[168:171], v[16:19], v[48:51]
    ds_read_b64_tr_b16 v[32:33], v4 offset:61440
    v_mfma_f32_16x16x32_bf16 v[64:67], a[172:175], v[16:19], v[64:67]
    ds_read_b64_tr_b16 v[34:35], v4 offset:63488
    s_add_u32 m0, s91, 81920
    s_add_u32 s32, s52, 2048
    buffer_load_dwordx4 v3, s[4:7], s32 offen sc1 lds
    v_mfma_f32_16x16x32_bf16 v[80:83], a[176:179], v[16:19], v[80:83]
    ds_read_b64_tr_b16 v[36:37], v5 offset:61440
    v_mfma_f32_16x16x32_bf16 v[96:99], v[16:19], v[16:19], v[96:99]
    s_waitcnt lgkmcnt(7)
    v_mfma_f32_16x16x32_bf16 v[52:55], a[168:171], v[20:23], v[52:55]
    ds_read_b64_tr_b16 v[38:39], v5 offset:63488
    v_mfma_f32_16x16x32_bf16 v[68:71], a[172:175], v[20:23], v[68:71]
    ds_read_b64_tr_b16 v[40:41], v6 offset:61440
    s_add_u32 m0, s91, 82944
    s_add_u32 s32, s52, 34816
    buffer_load_dwordx4 v3, s[4:7], s32 offen sc1 lds
    v_mfma_f32_16x16x32_bf16 v[84:87], a[176:179], v[20:23], v[84:87]
    ds_read_b64_tr_b16 v[42:43], v6 offset:63488
    s_waitcnt lgkmcnt(8)
    v_mfma_f32_16x16x32_bf16 v[56:59], a[168:171], v[24:27], v[56:59]
    ds_read_b64_tr_b16 v[44:45], v7 offset:61440
    v_mfma_f32_16x16x32_bf16 v[72:75], a[172:175], v[24:27], v[72:75]
    ds_read_b64_tr_b16 v[46:47], v7 offset:63488
    v_mfma_f32_16x16x32_bf16 v[88:91], a[176:179], v[24:27], v[88:91]
    v_mfma_f32_16x16x32_bf16 v[100:103], a[240:243], v[16:19], v[100:103]
    s_add_u32 m0, s91, 83968
    s_add_u32 s32, s52, 67584
    buffer_load_dwordx4 v3, s[4:7], s32 offen sc1 lds
    s_waitcnt lgkmcnt(8)
    v_mfma_f32_16x16x32_bf16 v[60:63], a[168:171], v[28:31], v[60:63]
    v_mfma_f32_16x16x32_bf16 v[76:79], a[172:175], v[28:31], v[76:79]
    v_mfma_f32_16x16x32_bf16 v[92:95], a[176:179], v[28:31], v[92:95]
    v_add_u32 v4, 0x10000, v4
    v_add_u32 v5, 0x10000, v5
    v_add_u32 v6, 0x10000, v6
    v_add_u32 v7, 0x10000, v7
    s_waitcnt lgkmcnt(6)
    v_mfma_f32_16x16x32_bf16 v[48:51], a[180:183], v[32:35], v[48:51]
    ds_read_b64_tr_b16 v[16:17], v4 offset:0
    v_mfma_f32_16x16x32_bf16 v[64:67], a[184:187], v[32:35], v[64:67]
    ds_read_b64_tr_b16 v[18:19], v4 offset:2048
    s_add_u32 m0, s91, 84992
    s_add_u32 s32, s52, 100352
    buffer_load_dwordx4 v3, s[4:7], s32 offen sc1 lds
    v_mfma_f32_16x16x32_bf16 v[80:83], a[188:191], v[32:35], v[80:83]
    ds_read_b64_tr_b16 v[20:21], v5 offset:0
    v_mfma_f32_16x16x32_bf16 v[96:99], v[32:35], v[32:35], v[96:99]
    s_waitcnt lgkmcnt(7)
    v_mfma_f32_16x16x32_bf16 v[52:55], a[180:183], v[36:39], v[52:55]
    ds_read_b64_tr_b16 v[22:23], v5 offset:2048
    v_mfma_f32_16x16x32_bf16 v[68:71], a[184:187], v[36:39], v[68:71]
    ds_read_b64_tr_b16 v[24:25], v6 offset:0
    s_add_u32 m0, s91, 86016
    s_add_u32 s32, s52, 133120
    buffer_load_dwordx4 v3, s[4:7], s32 offen sc1 lds
    v_mfma_f32_16x16x32_bf16 v[84:87], a[188:191], v[36:39], v[84:87]
    ds_read_b64_tr_b16 v[26:27], v6 offset:2048
    s_waitcnt lgkmcnt(8)
    v_mfma_f32_16x16x32_bf16 v[56:59], a[180:183], v[40:43], v[56:59]
    ds_read_b64_tr_b16 v[28:29], v7 offset:0
    v_mfma_f32_16x16x32_bf16 v[72:75], a[184:187], v[40:43], v[72:75]
    ds_read_b64_tr_b16 v[30:31], v7 offset:2048
    v_mfma_f32_16x16x32_bf16 v[88:91], a[188:191], v[40:43], v[88:91]
    v_mfma_f32_16x16x32_bf16 v[100:103], a[240:243], v[32:35], v[100:103]
    s_add_u32 m0, s91, 102400
    s_add_u32 s32, s53, 2048
    buffer_load_dwordx4 v3, s[4:7], s32 offen sc1 lds
    s_waitcnt lgkmcnt(8)
    v_mfma_f32_16x16x32_bf16 v[60:63], a[180:183], v[44:47], v[60:63]
    v_mfma_f32_16x16x32_bf16 v[76:79], a[184:187], v[44:47], v[76:79]
    v_mfma_f32_16x16x32_bf16 v[92:95], a[188:191], v[44:47], v[92:95]
    s_waitcnt lgkmcnt(6)
    v_mfma_f32_16x16x32_bf16 v[48:51], a[192:195], v[16:19], v[48:51]
    ds_read_b64_tr_b16 v[32:33], v4 offset:4096
    v_mfma_f32_16x16x32_bf16 v[64:67], a[196:199], v[16:19], v[64:67]
    ds_read_b64_tr_b16 v[34:35], v4 offset:6144
    s_add_u32 m0, s91, 103424
    s_add_u32 s32, s53, 34816
    buffer_load_dwordx4 v3, s[4:7], s32 offen sc1 lds
    v_mfma_f32_16x16x32_bf16 v[80:83], a[200:203], v[16:19], v[80:83]
    ds_read_b64_tr_b16 v[36:37], v5 offset:4096
    v_mfma_f32_16x16x32_bf16 v[96:99], v[16:19], v[16:19], v[96:99]
    s_waitcnt lgkmcnt(7)
    v_mfma_f32_16x16x32_bf16 v[52:55], a[192:195], v[20:23], v[52:55]
    ds_read_b64_tr_b16 v[38:39], v5 offset:6144
    v_mfma_f32_16x16x32_bf16 v[68:71], a[196:199], v[20:23], v[68:71]
    ds_read_b64_tr_b16 v[40:41], v6 offset:4096
    s_add_u32 m0, s91, 104448
    s_add_u32 s32, s53, 67584
    buffer_load_dwordx4 v3, s[4:7], s32 offen sc1 lds
    v_mfma_f32_16x16x32_bf16 v[84:87], a[200:203], v[20:23], v[84:87]
    ds_read_b64_tr_b16 v[42:43], v6 offset:6144
    s_waitcnt lgkmcnt(8)
    v_mfma_f32_16x16x32_bf16 v[56:59], a[192:195], v[24:27], v[56:59]
    ds_read_b64_tr_b16 v[44:45], v7 offset:4096
    v_mfma_f32_16x16x32_bf16 v[72:75], a[196:199], v[24:27], v[72:75]
    ds_read_b64_tr_b16 v[46:47], v7 offset:6144
    v_mfma_f32_16x16x32_bf16 v[88:91], a[200:203], v[24:27], v[88:91]
    v_mfma_f32_16x16x32_bf16 v[100:103], a[240:243], v[16:19], v[100:103]
    s_add_u32 m0, s91, 105472
    s_add_u32 s32, s53, 100352
    buffer_load_dwordx4 v3, s[4:7], s32 offen sc1 lds
    ds_read_b64_tr_b16 v[112:113], v12 offset:0
    ds_read_b64_tr_b16 v[114:115], v13 offset:512
    ds_read_b64_tr_b16 v[116:117], v12 offset:1024
    s_waitcnt lgkmcnt(11)
    v_mfma_f32_16x16x32_bf16 v[60:63], a[192:195], v[28:31], v[60:63]
    v_mfma_f32_16x16x32_bf16 v[76:79], a[196:199], v[28:31], v[76:79]
    v_mfma_f32_16x16x32_bf16 v[92:95], a[200:203], v[28:31], v[92:95]
    s_waitcnt lgkmcnt(9)
    v_mfma_f32_16x16x32_bf16 v[48:51], a[204:207], v[32:35], v[48:51]
    ds_read_b64_tr_b16 v[16:17], v4 offset:8192
    v_mfma_f32_16x16x32_bf16 v[64:67], a[208:211], v[32:35], v[64:67]
    ds_read_b64_tr_b16 v[18:19], v4 offset:10240
    s_add_u32 m0, s91, 106496
    s_add_u32 s32, s53, 133120
    buffer_load_dwordx4 v3, s[4:7], s32 offen sc1 lds
    v_mfma_f32_16x16x32_bf16 v[80:83], a[212:215], v[32:35], v[80:83]
    ds_read_b64_tr_b16 v[20:21], v5 offset:8192
    v_mfma_f32_16x16x32_bf16 v[96:99], v[32:35], v[32:35], v[96:99]
    s_waitcnt lgkmcnt(10)
    v_mfma_f32_16x16x32_bf16 v[52:55], a[204:207], v[36:39], v[52:55]
    ds_read_b64_tr_b16 v[22:23], v5 offset:10240
    v_mfma_f32_16x16x32_bf16 v[68:71], a[208:211], v[36:39], v[68:71]
    ds_read_b64_tr_b16 v[24:25], v6 offset:8192
    s_add_u32 m0, s91, 122880
    s_add_u32 s32, s54, 2048
    buffer_load_dwordx4 v3, s[4:7], s32 offen sc1 lds
    v_mfma_f32_16x16x32_bf16 v[84:87], a[212:215], v[36:39], v[84:87]
    ds_read_b64_tr_b16 v[26:27], v6 offset:10240
    s_waitcnt lgkmcnt(11)
    v_mfma_f32_16x16x32_bf16 v[56:59], a[204:207], v[40:43], v[56:59]
    ds_read_b64_tr_b16 v[28:29], v7 offset:8192
    v_mfma_f32_16x16x32_bf16 v[72:75], a[208:211], v[40:43], v[72:75]
    ds_read_b64_tr_b16 v[30:31], v7 offset:10240
    v_mfma_f32_16x16x32_bf16 v[88:91], a[212:215], v[40:43], v[88:91]
    v_mfma_f32_16x16x32_bf16 v[100:103], a[240:243], v[32:35], v[100:103]
    s_add_u32 m0, s91, 123904
    s_add_u32 s32, s54, 34816
    buffer_load_dwordx4 v3, s[4:7], s32 offen sc1 lds
    s_waitcnt lgkmcnt(11)
    v_mfma_f32_16x16x32_bf16 v[60:63], a[204:207], v[44:47], v[60:63]
    v_mfma_f32_16x16x32_bf16 v[76:79], a[208:211], v[44:47], v[76:79]
    v_mfma_f32_16x16x32_bf16 v[92:95], a[212:215], v[44:47], v[92:95]
    s_waitcnt lgkmcnt(6)
    v_mfma_f32_16x16x32_bf16 v[48:51], a[216:219], v[16:19], v[48:51]
    ds_read_b64_tr_b16 v[32:33], v4 offset:12288
    v_mfma_f32_16x16x32_bf16 v[64:67], a[220:223], v[16:19], v[64:67]
    ds_read_b64_tr_b16 v[34:35], v4 offset:14336
    s_add_u32 m0, s91, 124928
    s_add_u32 s32, s54, 67584
    buffer_load_dwordx4 v3, s[4:7], s32 offen sc1 lds
    v_mfma_f32_16x16x32_bf16 v[80:83], a[224:227], v[16:19], v[80:83]
    ds_read_b64_tr_b16 v[36:37], v5 offset:12288
    v_mfma_f32_16x16x32_bf16 v[96:99], v[16:19], v[16:19], v[96:99]
    s_waitcnt lgkmcnt(7)
    v_mfma_f32_16x16x32_bf16 v[52:55], a[216:219], v[20:23], v[52:55]
    ds_read_b64_tr_b16 v[38:39], v5 offset:14336
    v_mfma_f32_16x16x32_bf16 v[68:71], a[220:223], v[20:23], v[68:71]
    ds_read_b64_tr_b16 v[40:41], v6 offset:12288
    s_add_u32 m0, s91, 125952
    s_add_u32 s32, s54, 100352
    buffer_load_dwordx4 v3, s[4:7], s32 offen sc1 lds
    v_mfma_f32_16x16x32_bf16 v[84:87], a[224:227], v[20:23], v[84:87]
    ds_read_b64_tr_b16 v[42:43], v6 offset:14336
    s_waitcnt lgkmcnt(8)
    v_mfma_f32_16x16x32_bf16 v[56:59], a[216:219], v[24:27], v[56:59]
    ds_read_b64_tr_b16 v[44:45], v7 offset:12288
    v_mfma_f32_16x16x32_bf16 v[72:75], a[220:223], v[24:27], v[72:75]
    ds_read_b64_tr_b16 v[46:47], v7 offset:14336
    v_mfma_f32_16x16x32_bf16 v[88:91], a[224:227], v[24:27], v[88:91]
    v_mfma_f32_16x16x32_bf16 v[100:103], a[240:243], v[16:19], v[100:103]
    s_add_u32 m0, s91, 126976
    s_add_u32 s32, s54, 133120
    buffer_load_dwordx4 v3, s[4:7], s32 offen sc1 lds
    s_waitcnt lgkmcnt(8)
    v_mfma_f32_16x16x32_bf16 v[60:63], a[216:219], v[28:31], v[60:63]
    v_mfma_f32_16x16x32_bf16 v[76:79], a[220:223], v[28:31], v[76:79]
    v_mfma_f32_16x16x32_bf16 v[92:95], a[224:227], v[28:31], v[92:95]
    s_waitcnt lgkmcnt(6)
    v_mfma_f32_16x16x32_bf16 v[48:51], a[228:231], v[32:35], v[48:51]
    v_mfma_f32_16x16x32_bf16 v[96:99], v[32:35], v[32:35], v[96:99]
    v_mfma_f32_16x16x32_bf16 v[100:103], a[240:243], v[32:35], v[100:103]
    v_mfma_f32_16x16x32_bf16 v[64:67], a[232:235], v[32:35], v[64:67]
    s_add_u32 m0, s91, 143360
    s_add_u32 s32, s55, 2048
    buffer_load_dwordx4 v3, s[4:7], s32 offen sc1 lds
    v_mfma_f32_16x16x32_bf16 v[80:83], a[236:239], v[32:35], v[80:83]
    s_waitcnt lgkmcnt(4)
    v_mfma_f32_16x16x32_bf16 v[52:55], a[228:231], v[36:39], v[52:55]
    v_mfma_f32_16x16x32_bf16 v[68:71], a[232:235], v[36:39], v[68:71]
    s_add_u32 m0, s91, 144384
    s_add_u32 s32, s55, 34816
    buffer_load_dwordx4 v3, s[4:7], s32 offen sc1 lds
    v_mfma_f32_16x16x32_bf16 v[84:87], a[236:239], v[36:39], v[84:87]
    s_waitcnt lgkmcnt(2)
    v_mfma_f32_16x16x32_bf16 v[56:59], a[228:231], v[40:43], v[56:59]
    v_mfma_f32_16x16x32_bf16 v[72:75], a[232:235], v[40:43], v[72:75]
    v_cndmask_b32 v96, v96, v97, s[80:81]
    v_cndmask_b32 v98, v98, v99, s[80:81]
    v_mfma_f32_16x16x32_bf16 v[88:91], a[236:239], v[40:43], v[88:91]
    v_cndmask_b32 v97, v96, v98, s[60:61]
    v_mul_f32 v96, -0.0015625, v100
    s_add_u32 m0, s91, 145408
    s_add_u32 s32, s55, 67584
    buffer_load_dwordx4 v3, s[4:7], s32 offen sc1 lds
    s_waitcnt lgkmcnt(0)
    v_mfma_f32_16x16x32_bf16 v[60:63], a[228:231], v[44:47], v[60:63]
    v_mul_f32 v97, 0.0015625, v97
    v_fma_f32 v97, -v96, v96, v97
    v_mfma_f32_16x16x32_bf16 v[76:79], a[232:235], v[44:47], v[76:79]
    v_max_f32 v97, 0, v97
    v_add_f32 v97, 1e-05, v97
    v_mfma_f32_16x16x32_bf16 v[92:95], a[236:239], v[44:47], v[92:95]
    v_rcp_f32 v97, v97
    s_mov_b64 exec, s[62:63]
    ds_write2_b64 v14, v[96:97], v[96:97] offset0:0 offset1:64
    s_mov_b64 exec, -1
    v_add_u32 v4, 16384, v4
    v_add_u32 v5, 16384, v5
    v_add_u32 v6, 16384, v6
    v_add_u32 v7, 16384, v7
    s_waitcnt vmcnt(13)
    s_waitcnt lgkmcnt(0)
    s_barrier
    ds_read_b64 v[104:105], v14 offset:0
    ds_read_b64 v[106:107], v14 offset:128
    ds_read_b64 v[108:109], v14 offset:256
    ds_read_b64 v[110:111], v14 offset:384
    ds_read_b64_tr_b16 v[16:17], v4 offset:0
    ds_read_b64_tr_b16 v[18:19], v4 offset:2048
    ds_read_b64_tr_b16 v[20:21], v5 offset:0
    ds_read_b64_tr_b16 v[22:23], v5 offset:2048
    ds_read_b64_tr_b16 v[24:25], v6 offset:0
    ds_read_b64_tr_b16 v[26:27], v6 offset:2048
    ds_read_b64_tr_b16 v[28:29], v7 offset:0
    ds_read_b64_tr_b16 v[30:31], v7 offset:2048
    s_waitcnt lgkmcnt(11)
    v_pk_fma_f32 v[48:49], v[244:245], v[104:105], v[48:49] op_sel_hi:[1,0,1]
    v_pk_fma_f32 v[50:51], v[246:247], v[104:105], v[50:51] op_sel_hi:[1,0,1]
    v_pk_fma_f32 v[64:65], v[248:249], v[104:105], v[64:65] op_sel_hi:[1,0,1]
    v_pk_fma_f32 v[66:67], v[250:251], v[104:105], v[66:67] op_sel_hi:[1,0,1]
    v_pk_fma_f32 v[80:81], v[252:253], v[104:105], v[80:81] op_sel_hi:[1,0,1]
    v_pk_fma_f32 v[82:83], v[254:255], v[104:105], v[82:83] op_sel_hi:[1,0,1]
    s_add_u32 m0, s91, 146432
    s_add_u32 s32, s55, 100352
    buffer_load_dwordx4 v3, s[4:7], s32 offen sc1 lds
    s_waitcnt lgkmcnt(10)
    v_pk_fma_f32 v[52:53], v[244:245], v[106:107], v[52:53] op_sel_hi:[1,0,1]
    v_pk_fma_f32 v[54:55], v[246:247], v[106:107], v[54:55] op_sel_hi:[1,0,1]
    v_pk_fma_f32 v[68:69], v[248:249], v[106:107], v[68:69] op_sel_hi:[1,0,1]
    v_pk_fma_f32 v[70:71], v[250:251], v[106:107], v[70:71] op_sel_hi:[1,0,1]
    v_pk_fma_f32 v[84:85], v[252:253], v[106:107], v[84:85] op_sel_hi:[1,0,1]
    v_pk_fma_f32 v[86:87], v[254:255], v[106:107], v[86:87] op_sel_hi:[1,0,1]
    s_add_u32 m0, s91, 147456
    s_add_u32 s32, s55, 133120
    buffer_load_dwordx4 v3, s[4:7], s32 offen sc1 lds
    s_waitcnt lgkmcnt(9)
    v_pk_fma_f32 v[56:57], v[244:245], v[108:109], v[56:57] op_sel_hi:[1,0,1]
    v_pk_fma_f32 v[58:59], v[246:247], v[108:109], v[58:59] op_sel_hi:[1,0,1]
    v_pk_fma_f32 v[72:73], v[248:249], v[108:109], v[72:73] op_sel_hi:[1,0,1]
    v_pk_fma_f32 v[74:75], v[250:251], v[108:109], v[74:75] op_sel_hi:[1,0,1]
    v_pk_fma_f32 v[88:89], v[252:253], v[108:109], v[88:89] op_sel_hi:[1,0,1]
    v_pk_fma_f32 v[90:91], v[254:255], v[108:109], v[90:91] op_sel_hi:[1,0,1]
    s_waitcnt lgkmcnt(8)
    v_pk_fma_f32 v[60:61], v[244:245], v[110:111], v[60:61] op_sel_hi:[1,0,1]
    v_pk_fma_f32 v[62:63], v[246:247], v[110:111], v[62:63] op_sel_hi:[1,0,1]
    v_pk_fma_f32 v[76:77], v[248:249], v[110:111], v[76:77] op_sel_hi:[1,0,1]
    v_pk_fma_f32 v[78:79], v[250:251], v[110:111], v[78:79] op_sel_hi:[1,0,1]
    v_pk_fma_f32 v[92:93], v[252:253], v[110:111], v[92:93] op_sel_hi:[1,0,1]
    v_pk_fma_f32 v[94:95], v[254:255], v[110:111], v[94:95] op_sel_hi:[1,0,1]
    v_cndmask_b32 v118, v107, v105, s[82:83]
    v_cndmask_b32 v120, v111, v109, s[82:83]
    v_pk_mul_f32 v[48:49], v[48:49], v[64:65]
    v_pk_mul_f32 v[50:51], v[50:51], v[66:67]
    v_pk_mul_f32 v[52:53], v[52:53], v[68:69]
    v_pk_mul_f32 v[54:55], v[54:55], v[70:71]
    v_permlane32_swap_b32 v80, v84
    v_permlane32_swap_b32 v81, v85
    v_permlane32_swap_b32 v82, v86
    v_permlane32_swap_b32 v83, v87
    v_pk_mul_f32 v[48:49], v[48:49], v[104:105] op_sel:[0,1] op_sel_hi:[1,1]
    v_pk_mul_f32 v[50:51], v[50:51], v[104:105] op_sel:[0,1] op_sel_hi:[1,1]
    v_pk_mul_f32 v[52:53], v[52:53], v[106:107] op_sel:[0,1] op_sel_hi:[1,1]
    v_pk_mul_f32 v[54:55], v[54:55], v[106:107] op_sel:[0,1] op_sel_hi:[1,1]
    v_pk_mul_f32 v[80:81], v[80:81], v[84:85]
    v_pk_mul_f32 v[82:83], v[82:83], v[86:87]
    v_cvt_pk_bf16_f32 v32, v48, v49
    v_cvt_pk_bf16_f32 v33, v50, v51
    v_cvt_pk_bf16_f32 v34, v52, v53
    v_cvt_pk_bf16_f32 v35, v54, v55
    v_pk_mul_f32 v[80:81], v[80:81], v[118:119] op_sel_hi:[1,0]
    v_pk_mul_f32 v[82:83], v[82:83], v[118:119] op_sel_hi:[1,0]
    v_permlane16_swap_b32 v32, v34
    v_permlane16_swap_b32 v33, v35
    v_cvt_pk_bf16_f32 v40, v80, v81
    v_cvt_pk_bf16_f32 v41, v82, v83
    buffer_store_dwordx4 v[32:35], v8, s[4:7], s94 offen sc1
    v_pk_mul_f32 v[56:57], v[56:57], v[72:73]
    v_pk_mul_f32 v[58:59], v[58:59], v[74:75]
    v_pk_mul_f32 v[60:61], v[60:61], v[76:77]
    v_pk_mul_f32 v[62:63], v[62:63], v[78:79]
    v_permlane32_swap_b32 v88, v92
    v_permlane32_swap_b32 v89, v93
    v_permlane32_swap_b32 v90, v94
    v_permlane32_swap_b32 v91, v95
    v_pk_mul_f32 v[56:57], v[56:57], v[108:109] op_sel:[0,1] op_sel_hi:[1,1]
    v_pk_mul_f32 v[58:59], v[58:59], v[108:109] op_sel:[0,1] op_sel_hi:[1,1]
    v_pk_mul_f32 v[60:61], v[60:61], v[110:111] op_sel:[0,1] op_sel_hi:[1,1]
    v_pk_mul_f32 v[62:63], v[62:63], v[110:111] op_sel:[0,1] op_sel_hi:[1,1]
    v_pk_mul_f32 v[88:89], v[88:89], v[92:93]
    v_pk_mul_f32 v[90:91], v[90:91], v[94:95]
    v_cvt_pk_bf16_f32 v36, v56, v57
    v_cvt_pk_bf16_f32 v37, v58, v59
    v_cvt_pk_bf16_f32 v38, v60, v61
    v_cvt_pk_bf16_f32 v39, v62, v63
    v_pk_mul_f32 v[88:89], v[88:89], v[120:121] op_sel_hi:[1,0]
    v_pk_mul_f32 v[90:91], v[90:91], v[120:121] op_sel_hi:[1,0]
    v_permlane16_swap_b32 v36, v38
    v_permlane16_swap_b32 v37, v39
    v_cvt_pk_bf16_f32 v42, v88, v89
    v_cvt_pk_bf16_f32 v43, v90, v91
    buffer_store_dwordx4 v[36:39], v9, s[4:7], s94 offen sc1
    s_nop 0
    v_permlane16_swap_b32 v40, v42
    v_permlane16_swap_b32 v41, v43
    buffer_store_dwordx4 v[40:43], v10, s[4:7], s94 offen offset:512 sc1
    v_add_u32 v14, s93, v14
    s_add_u32 s94, s94, 3145728
    s_waitcnt lgkmcnt(6)
    v_mfma_f32_16x16x32_bf16 v[48:51], a[0:3], v[16:19], 0
    ds_read_b64_tr_b16 v[32:33], v4 offset:4096
    v_mfma_f32_16x16x32_bf16 v[64:67], a[4:7], v[16:19], 0
    ds_read_b64_tr_b16 v[34:35], v4 offset:6144
    v_mfma_f32_16x16x32_bf16 v[80:83], a[8:11], v[16:19], 0
    ds_read_b64_tr_b16 v[36:37], v5 offset:4096
    v_mfma_f32_16x16x32_bf16 v[96:99], v[16:19], v[16:19], 0
    s_waitcnt lgkmcnt(7)
    v_mfma_f32_16x16x32_bf16 v[52:55], a[0:3], v[20:23], 0
    ds_read_b64_tr_b16 v[38:39], v5 offset:6144
    v_mfma_f32_16x16x32_bf16 v[68:71], a[4:7], v[20:23], 0
    ds_read_b64_tr_b16 v[40:41], v6 offset:4096
    v_mfma_f32_16x16x32_bf16 v[84:87], a[8:11], v[20:23], 0
    ds_read_b64_tr_b16 v[42:43], v6 offset:6144
    s_waitcnt lgkmcnt(8)
    v_mfma_f32_16x16x32_bf16 v[56:59], a[0:3], v[24:27], 0
    ds_read_b64_tr_b16 v[44:45], v7 offset:4096
    v_mfma_f32_16x16x32_bf16 v[72:75], a[4:7], v[24:27], 0
    ds_read_b64_tr_b16 v[46:47], v7 offset:6144
    v_mfma_f32_16x16x32_bf16 v[88:91], a[8:11], v[24:27], 0
    v_mfma_f32_16x16x32_bf16 v[100:103], a[240:243], v[16:19], 0
    s_waitcnt lgkmcnt(8)
    v_mfma_f32_16x16x32_bf16 v[60:63], a[0:3], v[28:31], 0
    v_mfma_f32_16x16x32_bf16 v[76:79], a[4:7], v[28:31], 0
    v_mfma_f32_16x16x32_bf16 v[92:95], a[8:11], v[28:31], 0
    s_waitcnt lgkmcnt(6)
    v_mfma_f32_16x16x32_bf16 v[48:51], a[12:15], v[32:35], v[48:51]
    ds_read_b64_tr_b16 v[16:17], v4 offset:8192
    v_mfma_f32_16x16x32_bf16 v[64:67], a[16:19], v[32:35], v[64:67]
    ds_read_b64_tr_b16 v[18:19], v4 offset:10240
    buffer_load_dwordx4 a[0:3], v2, s[4:7], s90 offen offset:2048 sc1
    v_mfma_f32_16x16x32_bf16 v[80:83], a[20:23], v[32:35], v[80:83]
    ds_read_b64_tr_b16 v[20:21], v5 offset:8192
    v_mfma_f32_16x16x32_bf16 v[96:99], v[32:35], v[32:35], v[96:99]
    s_waitcnt lgkmcnt(7)
    v_mfma_f32_16x16x32_bf16 v[52:55], a[12:15], v[36:39], v[52:55]
    ds_read_b64_tr_b16 v[22:23], v5 offset:10240
    v_mfma_f32_16x16x32_bf16 v[68:71], a[16:19], v[36:39], v[68:71]
    ds_read_b64_tr_b16 v[24:25], v6 offset:8192
    buffer_load_dwordx4 a[4:7], v2, s[4:7], s90 offen offset:3072 sc1
    v_mfma_f32_16x16x32_bf16 v[84:87], a[20:23], v[36:39], v[84:87]
    ds_read_b64_tr_b16 v[26:27], v6 offset:10240
    s_waitcnt lgkmcnt(8)
    v_mfma_f32_16x16x32_bf16 v[56:59], a[12:15], v[40:43], v[56:59]
    ds_read_b64_tr_b16 v[28:29], v7 offset:8192
    v_mfma_f32_16x16x32_bf16 v[72:75], a[16:19], v[40:43], v[72:75]
    ds_read_b64_tr_b16 v[30:31], v7 offset:10240
    v_mfma_f32_16x16x32_bf16 v[88:91], a[20:23], v[40:43], v[88:91]
    v_mfma_f32_16x16x32_bf16 v[100:103], a[240:243], v[32:35], v[100:103]
    s_add_u32 s90, s90, 4096
    buffer_load_dwordx4 a[8:11], v2, s[4:7], s90 offen offset:0 sc1
    s_waitcnt lgkmcnt(8)
    v_mfma_f32_16x16x32_bf16 v[60:63], a[12:15], v[44:47], v[60:63]
    v_mfma_f32_16x16x32_bf16 v[76:79], a[16:19], v[44:47], v[76:79]
    v_mfma_f32_16x16x32_bf16 v[92:95], a[20:23], v[44:47], v[92:95]
    s_waitcnt lgkmcnt(6)
    v_mfma_f32_16x16x32_bf16 v[48:51], a[24:27], v[16:19], v[48:51]
    ds_read_b64_tr_b16 v[32:33], v4 offset:12288
    v_mfma_f32_16x16x32_bf16 v[64:67], a[28:31], v[16:19], v[64:67]
    ds_read_b64_tr_b16 v[34:35], v4 offset:14336
    buffer_load_dwordx4 a[12:15], v2, s[4:7], s90 offen offset:1024 sc1
    v_mfma_f32_16x16x32_bf16 v[80:83], a[32:35], v[16:19], v[80:83]
    ds_read_b64_tr_b16 v[36:37], v5 offset:12288
    v_mfma_f32_16x16x32_bf16 v[96:99], v[16:19], v[16:19], v[96:99]
    s_waitcnt lgkmcnt(7)
    v_mfma_f32_16x16x32_bf16 v[52:55], a[24:27], v[20:23], v[52:55]
    ds_read_b64_tr_b16 v[38:39], v5 offset:14336
    v_mfma_f32_16x16x32_bf16 v[68:71], a[28:31], v[20:23], v[68:71]
    ds_read_b64_tr_b16 v[40:41], v6 offset:12288
    buffer_load_dwordx4 a[16:19], v2, s[4:7], s90 offen offset:2048 sc1
    v_mfma_f32_16x16x32_bf16 v[84:87], a[32:35], v[20:23], v[84:87]
    ds_read_b64_tr_b16 v[42:43], v6 offset:14336
    s_waitcnt lgkmcnt(8)
    v_mfma_f32_16x16x32_bf16 v[56:59], a[24:27], v[24:27], v[56:59]
    ds_read_b64_tr_b16 v[44:45], v7 offset:12288
    v_mfma_f32_16x16x32_bf16 v[72:75], a[28:31], v[24:27], v[72:75]
    ds_read_b64_tr_b16 v[46:47], v7 offset:14336
    v_mfma_f32_16x16x32_bf16 v[88:91], a[32:35], v[24:27], v[88:91]
    v_mfma_f32_16x16x32_bf16 v[100:103], a[240:243], v[16:19], v[100:103]
    buffer_load_dwordx4 a[20:23], v2, s[4:7], s90 offen offset:3072 sc1
    s_waitcnt lgkmcnt(8)
    v_mfma_f32_16x16x32_bf16 v[60:63], a[24:27], v[28:31], v[60:63]
    v_mfma_f32_16x16x32_bf16 v[76:79], a[28:31], v[28:31], v[76:79]
    v_mfma_f32_16x16x32_bf16 v[92:95], a[32:35], v[28:31], v[92:95]
    s_waitcnt lgkmcnt(6)
    v_mfma_f32_16x16x32_bf16 v[48:51], a[36:39], v[32:35], v[48:51]
    ds_read_b64_tr_b16 v[16:17], v4 offset:16384
    v_mfma_f32_16x16x32_bf16 v[64:67], a[40:43], v[32:35], v[64:67]
    ds_read_b64_tr_b16 v[18:19], v4 offset:18432
    s_add_u32 s90, s90, 4096
    buffer_load_dwordx4 a[24:27], v2, s[4:7], s90 offen offset:0 sc1
    v_mfma_f32_16x16x32_bf16 v[80:83], a[44:47], v[32:35], v[80:83]
    ds_read_b64_tr_b16 v[20:21], v5 offset:16384
    v_mfma_f32_16x16x32_bf16 v[96:99], v[32:35], v[32:35], v[96:99]
    s_waitcnt lgkmcnt(7)
    v_mfma_f32_16x16x32_bf16 v[52:55], a[36:39], v[36:39], v[52:55]
    ds_read_b64_tr_b16 v[22:23], v5 offset:18432
    v_mfma_f32_16x16x32_bf16 v[68:71], a[40:43], v[36:39], v[68:71]
    ds_read_b64_tr_b16 v[24:25], v6 offset:16384
    buffer_load_dwordx4 a[28:31], v2, s[4:7], s90 offen offset:1024 sc1
    v_mfma_f32_16x16x32_bf16 v[84:87], a[44:47], v[36:39], v[84:87]
    ds_read_b64_tr_b16 v[26:27], v6 offset:18432
    s_waitcnt lgkmcnt(8)
    v_mfma_f32_16x16x32_bf16 v[56:59], a[36:39], v[40:43], v[56:59]
    ds_read_b64_tr_b16 v[28:29], v7 offset:16384
    v_mfma_f32_16x16x32_bf16 v[72:75], a[40:43], v[40:43], v[72:75]
    ds_read_b64_tr_b16 v[30:31], v7 offset:18432
    v_mfma_f32_16x16x32_bf16 v[88:91], a[44:47], v[40:43], v[88:91]
    v_mfma_f32_16x16x32_bf16 v[100:103], a[240:243], v[32:35], v[100:103]
    buffer_load_dwordx4 a[32:35], v2, s[4:7], s90 offen offset:2048 sc1
    s_waitcnt lgkmcnt(8)
    v_mfma_f32_16x16x32_bf16 v[60:63], a[36:39], v[44:47], v[60:63]
    v_mfma_f32_16x16x32_bf16 v[76:79], a[40:43], v[44:47], v[76:79]
    v_mfma_f32_16x16x32_bf16 v[92:95], a[44:47], v[44:47], v[92:95]
    s_waitcnt vmcnt(22)
    s_barrier
    s_waitcnt lgkmcnt(6)
    v_mfma_f32_16x16x32_bf16 v[48:51], a[48:51], v[16:19], v[48:51]
    ds_read_b64_tr_b16 v[32:33], v4 offset:20480
    v_mfma_f32_16x16x32_bf16 v[64:67], a[52:55], v[16:19], v[64:67]
    ds_read_b64_tr_b16 v[34:35], v4 offset:22528
    buffer_load_dwordx4 a[36:39], v2, s[4:7], s90 offen offset:3072 sc1
    v_mfma_f32_16x16x32_bf16 v[80:83], a[56:59], v[16:19], v[80:83]
    ds_read_b64_tr_b16 v[36:37], v5 offset:20480
    v_mfma_f32_16x16x32_bf16 v[96:99], v[16:19], v[16:19], v[96:99]
    s_waitcnt lgkmcnt(7)
    v_mfma_f32_16x16x32_bf16 v[52:55], a[48:51], v[20:23], v[52:55]
    ds_read_b64_tr_b16 v[38:39], v5 offset:22528
    v_mfma_f32_16x16x32_bf16 v[68:71], a[52:55], v[20:23], v[68:71]
    ds_read_b64_tr_b16 v[40:41], v6 offset:20480
    s_add_u32 s90, s90, 4096
    buffer_load_dwordx4 a[40:43], v2, s[4:7], s90 offen offset:0 sc1
    v_mfma_f32_16x16x32_bf16 v[84:87], a[56:59], v[20:23], v[84:87]
    ds_read_b64_tr_b16 v[42:43], v6 offset:22528
    s_waitcnt lgkmcnt(8)
    v_mfma_f32_16x16x32_bf16 v[56:59], a[48:51], v[24:27], v[56:59]
    ds_read_b64_tr_b16 v[44:45], v7 offset:20480
    v_mfma_f32_16x16x32_bf16 v[72:75], a[52:55], v[24:27], v[72:75]
    ds_read_b64_tr_b16 v[46:47], v7 offset:22528
    v_mfma_f32_16x16x32_bf16 v[88:91], a[56:59], v[24:27], v[88:91]
    v_mfma_f32_16x16x32_bf16 v[100:103], a[240:243], v[16:19], v[100:103]
    buffer_load_dwordx4 a[44:47], v2, s[4:7], s90 offen offset:1024 sc1
    s_waitcnt vmcnt(12)
    s_mov_b64 exec, 1
    buffer_store_dword v0, v15, s[4:7], s85 offen sc1
    s_mov_b64 exec, -1
    s_waitcnt lgkmcnt(8)
    v_mfma_f32_16x16x32_bf16 v[60:63], a[48:51], v[28:31], v[60:63]
    v_mfma_f32_16x16x32_bf16 v[76:79], a[52:55], v[28:31], v[76:79]
    v_mfma_f32_16x16x32_bf16 v[92:95], a[56:59], v[28:31], v[92:95]
    s_waitcnt lgkmcnt(6)
    v_mfma_f32_16x16x32_bf16 v[48:51], a[60:63], v[32:35], v[48:51]
    ds_read_b64_tr_b16 v[16:17], v4 offset:24576
    v_mfma_f32_16x16x32_bf16 v[64:67], a[64:67], v[32:35], v[64:67]
    ds_read_b64_tr_b16 v[18:19], v4 offset:26624
    buffer_load_dwordx4 a[48:51], v2, s[4:7], s90 offen offset:2048 sc1
    v_mfma_f32_16x16x32_bf16 v[80:83], a[68:71], v[32:35], v[80:83]
    ds_read_b64_tr_b16 v[20:21], v5 offset:24576
    v_mfma_f32_16x16x32_bf16 v[96:99], v[32:35], v[32:35], v[96:99]
    s_waitcnt lgkmcnt(7)
    v_mfma_f32_16x16x32_bf16 v[52:55], a[60:63], v[36:39], v[52:55]
    ds_read_b64_tr_b16 v[22:23], v5 offset:26624
    v_mfma_f32_16x16x32_bf16 v[68:71], a[64:67], v[36:39], v[68:71]
    ds_read_b64_tr_b16 v[24:25], v6 offset:24576
    buffer_load_dwordx4 a[52:55], v2, s[4:7], s90 offen offset:3072 sc1
    v_mfma_f32_16x16x32_bf16 v[84:87], a[68:71], v[36:39], v[84:87]
    ds_read_b64_tr_b16 v[26:27], v6 offset:26624
    s_waitcnt lgkmcnt(8)
    v_mfma_f32_16x16x32_bf16 v[56:59], a[60:63], v[40:43], v[56:59]
    ds_read_b64_tr_b16 v[28:29], v7 offset:24576
    v_mfma_f32_16x16x32_bf16 v[72:75], a[64:67], v[40:43], v[72:75]
    ds_read_b64_tr_b16 v[30:31], v7 offset:26624
    v_mfma_f32_16x16x32_bf16 v[88:91], a[68:71], v[40:43], v[88:91]
    v_mfma_f32_16x16x32_bf16 v[100:103], a[240:243], v[32:35], v[100:103]
    s_add_u32 s90, s90, 4096
    buffer_load_dwordx4 a[56:59], v2, s[4:7], s90 offen offset:0 sc1
    s_waitcnt lgkmcnt(8)
    v_mfma_f32_16x16x32_bf16 v[60:63], a[60:63], v[44:47], v[60:63]
    v_mfma_f32_16x16x32_bf16 v[76:79], a[64:67], v[44:47], v[76:79]
    v_mfma_f32_16x16x32_bf16 v[92:95], a[68:71], v[44:47], v[92:95]
    s_waitcnt lgkmcnt(6)
    v_mfma_f32_16x16x32_bf16 v[48:51], a[72:75], v[16:19], v[48:51]
    ds_read_b64_tr_b16 v[32:33], v4 offset:28672
    v_mfma_f32_16x16x32_bf16 v[64:67], a[76:79], v[16:19], v[64:67]
    ds_read_b64_tr_b16 v[34:35], v4 offset:30720
    buffer_load_dwordx4 a[60:63], v2, s[4:7], s90 offen offset:1024 sc1
    v_mfma_f32_16x16x32_bf16 v[80:83], a[80:83], v[16:19], v[80:83]
    ds_read_b64_tr_b16 v[36:37], v5 offset:28672
    v_mfma_f32_16x16x32_bf16 v[96:99], v[16:19], v[16:19], v[96:99]
    s_waitcnt lgkmcnt(7)
    v_mfma_f32_16x16x32_bf16 v[52:55], a[72:75], v[20:23], v[52:55]
    ds_read_b64_tr_b16 v[38:39], v5 offset:30720
    v_mfma_f32_16x16x32_bf16 v[68:71], a[76:79], v[20:23], v[68:71]
    ds_read_b64_tr_b16 v[40:41], v6 offset:28672
    buffer_load_dwordx4 a[64:67], v2, s[4:7], s90 offen offset:2048 sc1
    v_mfma_f32_16x16x32_bf16 v[84:87], a[80:83], v[20:23], v[84:87]
    ds_read_b64_tr_b16 v[42:43], v6 offset:30720
    s_waitcnt lgkmcnt(8)
    v_mfma_f32_16x16x32_bf16 v[56:59], a[72:75], v[24:27], v[56:59]
    ds_read_b64_tr_b16 v[44:45], v7 offset:28672
    v_mfma_f32_16x16x32_bf16 v[72:75], a[76:79], v[24:27], v[72:75]
    ds_read_b64_tr_b16 v[46:47], v7 offset:30720
    v_mfma_f32_16x16x32_bf16 v[88:91], a[80:83], v[24:27], v[88:91]
    v_mfma_f32_16x16x32_bf16 v[100:103], a[240:243], v[16:19], v[100:103]
    buffer_load_dwordx4 a[68:71], v2, s[4:7], s90 offen offset:3072 sc1
    s_waitcnt lgkmcnt(8)
    v_mfma_f32_16x16x32_bf16 v[60:63], a[72:75], v[28:31], v[60:63]
    v_mfma_f32_16x16x32_bf16 v[76:79], a[76:79], v[28:31], v[76:79]
    v_mfma_f32_16x16x32_bf16 v[92:95], a[80:83], v[28:31], v[92:95]
    s_waitcnt lgkmcnt(6)
    v_mfma_f32_16x16x32_bf16 v[48:51], a[84:87], v[32:35], v[48:51]
    ds_read_b64_tr_b16 v[16:17], v4 offset:32768
    v_mfma_f32_16x16x32_bf16 v[64:67], a[88:91], v[32:35], v[64:67]
    ds_read_b64_tr_b16 v[18:19], v4 offset:34816
    s_add_u32 s90, s90, 4096
    buffer_load_dwordx4 a[72:75], v2, s[4:7], s90 offen offset:0 sc1
    v_mfma_f32_16x16x32_bf16 v[80:83], a[92:95], v[32:35], v[80:83]
    ds_read_b64_tr_b16 v[20:21], v5 offset:32768
    v_mfma_f32_16x16x32_bf16 v[96:99], v[32:35], v[32:35], v[96:99]
    s_waitcnt lgkmcnt(7)
    v_mfma_f32_16x16x32_bf16 v[52:55], a[84:87], v[36:39], v[52:55]
    ds_read_b64_tr_b16 v[22:23], v5 offset:34816
    v_mfma_f32_16x16x32_bf16 v[68:71], a[88:91], v[36:39], v[68:71]
    ds_read_b64_tr_b16 v[24:25], v6 offset:32768
    buffer_load_dwordx4 a[76:79], v2, s[4:7], s90 offen offset:1024 sc1
    v_mfma_f32_16x16x32_bf16 v[84:87], a[92:95], v[36:39], v[84:87]
    ds_read_b64_tr_b16 v[26:27], v6 offset:34816
    s_waitcnt lgkmcnt(8)
    v_mfma_f32_16x16x32_bf16 v[56:59], a[84:87], v[40:43], v[56:59]
    ds_read_b64_tr_b16 v[28:29], v7 offset:32768
    v_mfma_f32_16x16x32_bf16 v[72:75], a[88:91], v[40:43], v[72:75]
    ds_read_b64_tr_b16 v[30:31], v7 offset:34816
    v_mfma_f32_16x16x32_bf16 v[88:91], a[92:95], v[40:43], v[88:91]
    v_mfma_f32_16x16x32_bf16 v[100:103], a[240:243], v[32:35], v[100:103]
    buffer_load_dwordx4 a[80:83], v2, s[4:7], s90 offen offset:2048 sc1
    s_waitcnt lgkmcnt(8)
    v_mfma_f32_16x16x32_bf16 v[60:63], a[84:87], v[44:47], v[60:63]
    v_mfma_f32_16x16x32_bf16 v[76:79], a[88:91], v[44:47], v[76:79]
    v_mfma_f32_16x16x32_bf16 v[92:95], a[92:95], v[44:47], v[92:95]
    s_waitcnt lgkmcnt(6)
    v_mfma_f32_16x16x32_bf16 v[48:51], a[96:99], v[16:19], v[48:51]
    ds_read_b64_tr_b16 v[32:33], v4 offset:36864
    v_mfma_f32_16x16x32_bf16 v[64:67], a[100:103], v[16:19], v[64:67]
    ds_read_b64_tr_b16 v[34:35], v4 offset:38912
    buffer_load_dwordx4 a[84:87], v2, s[4:7], s90 offen offset:3072 sc1
    v_mfma_f32_16x16x32_bf16 v[80:83], a[104:107], v[16:19], v[80:83]
    ds_read_b64_tr_b16 v[36:37], v5 offset:36864
    v_mfma_f32_16x16x32_bf16 v[96:99], v[16:19], v[16:19], v[96:99]
    s_waitcnt lgkmcnt(7)
    v_mfma_f32_16x16x32_bf16 v[52:55], a[96:99], v[20:23], v[52:55]
    ds_read_b64_tr_b16 v[38:39], v5 offset:38912
    v_mfma_f32_16x16x32_bf16 v[68:71], a[100:103], v[20:23], v[68:71]
    ds_read_b64_tr_b16 v[40:41], v6 offset:36864
    s_add_u32 s90, s90, 4096
    buffer_load_dwordx4 a[88:91], v2, s[4:7], s90 offen offset:0 sc1
    v_mfma_f32_16x16x32_bf16 v[84:87], a[104:107], v[20:23], v[84:87]
    ds_read_b64_tr_b16 v[42:43], v6 offset:38912
    s_waitcnt lgkmcnt(8)
    v_mfma_f32_16x16x32_bf16 v[56:59], a[96:99], v[24:27], v[56:59]
    ds_read_b64_tr_b16 v[44:45], v7 offset:36864
    v_mfma_f32_16x16x32_bf16 v[72:75], a[100:103], v[24:27], v[72:75]
    ds_read_b64_tr_b16 v[46:47], v7 offset:38912
    v_mfma_f32_16x16x32_bf16 v[88:91], a[104:107], v[24:27], v[88:91]
    v_mfma_f32_16x16x32_bf16 v[100:103], a[240:243], v[16:19], v[100:103]
    buffer_load_dwordx4 a[92:95], v2, s[4:7], s90 offen offset:1024 sc1
    s_waitcnt lgkmcnt(8)
    v_mfma_f32_16x16x32_bf16 v[60:63], a[96:99], v[28:31], v[60:63]
    v_mfma_f32_16x16x32_bf16 v[76:79], a[100:103], v[28:31], v[76:79]
    v_mfma_f32_16x16x32_bf16 v[92:95], a[104:107], v[28:31], v[92:95]
    s_barrier
    s_waitcnt lgkmcnt(6)
    v_mfma_f32_16x16x32_bf16 v[48:51], a[108:111], v[32:35], v[48:51]
    ds_read_b64_tr_b16 v[16:17], v4 offset:40960
    v_mfma_f32_16x16x32_bf16 v[64:67], a[112:115], v[32:35], v[64:67]
    ds_read_b64_tr_b16 v[18:19], v4 offset:43008
    buffer_load_dwordx4 a[96:99], v2, s[4:7], s90 offen offset:2048 sc1
    v_mfma_f32_16x16x32_bf16 v[80:83], a[116:119], v[32:35], v[80:83]
    ds_read_b64_tr_b16 v[20:21], v5 offset:40960
    v_mfma_f32_16x16x32_bf16 v[96:99], v[32:35], v[32:35], v[96:99]
    s_waitcnt lgkmcnt(7)
    v_mfma_f32_16x16x32_bf16 v[52:55], a[108:111], v[36:39], v[52:55]
    ds_read_b64_tr_b16 v[22:23], v5 offset:43008
    v_mfma_f32_16x16x32_bf16 v[68:71], a[112:115], v[36:39], v[68:71]
    ds_read_b64_tr_b16 v[24:25], v6 offset:40960
    buffer_load_dwordx4 a[100:103], v2, s[4:7], s90 offen offset:3072 sc1
    v_mfma_f32_16x16x32_bf16 v[84:87], a[116:119], v[36:39], v[84:87]
    ds_read_b64_tr_b16 v[26:27], v6 offset:43008
    s_waitcnt lgkmcnt(8)
    v_mfma_f32_16x16x32_bf16 v[56:59], a[108:111], v[40:43], v[56:59]
    ds_read_b64_tr_b16 v[28:29], v7 offset:40960
    v_mfma_f32_16x16x32_bf16 v[72:75], a[112:115], v[40:43], v[72:75]
    ds_read_b64_tr_b16 v[30:31], v7 offset:43008
    v_mfma_f32_16x16x32_bf16 v[88:91], a[116:119], v[40:43], v[88:91]
    v_mfma_f32_16x16x32_bf16 v[100:103], a[240:243], v[32:35], v[100:103]
    s_add_u32 s90, s90, 4096
    buffer_load_dwordx4 a[104:107], v2, s[4:7], s90 offen offset:0 sc1
    s_waitcnt lgkmcnt(8)
    v_mfma_f32_16x16x32_bf16 v[60:63], a[108:111], v[44:47], v[60:63]
    v_mfma_f32_16x16x32_bf16 v[76:79], a[112:115], v[44:47], v[76:79]
    v_mfma_f32_16x16x32_bf16 v[92:95], a[116:119], v[44:47], v[92:95]
    s_waitcnt lgkmcnt(6)
    v_mfma_f32_16x16x32_bf16 v[48:51], a[120:123], v[16:19], v[48:51]
    ds_read_b64_tr_b16 v[32:33], v4 offset:45056
    v_mfma_f32_16x16x32_bf16 v[64:67], a[124:127], v[16:19], v[64:67]
    ds_read_b64_tr_b16 v[34:35], v4 offset:47104
    buffer_load_dwordx4 a[108:111], v2, s[4:7], s90 offen offset:1024 sc1
    v_mfma_f32_16x16x32_bf16 v[80:83], a[128:131], v[16:19], v[80:83]
    ds_read_b64_tr_b16 v[36:37], v5 offset:45056
    v_mfma_f32_16x16x32_bf16 v[96:99], v[16:19], v[16:19], v[96:99]
    s_waitcnt lgkmcnt(7)
    v_mfma_f32_16x16x32_bf16 v[52:55], a[120:123], v[20:23], v[52:55]
    ds_read_b64_tr_b16 v[38:39], v5 offset:47104
    v_mfma_f32_16x16x32_bf16 v[68:71], a[124:127], v[20:23], v[68:71]
    ds_read_b64_tr_b16 v[40:41], v6 offset:45056
    buffer_load_dwordx4 a[112:115], v2, s[4:7], s90 offen offset:2048 sc1
    v_mfma_f32_16x16x32_bf16 v[84:87], a[128:131], v[20:23], v[84:87]
    ds_read_b64_tr_b16 v[42:43], v6 offset:47104
    s_waitcnt lgkmcnt(8)
    v_mfma_f32_16x16x32_bf16 v[56:59], a[120:123], v[24:27], v[56:59]
    ds_read_b64_tr_b16 v[44:45], v7 offset:45056
    v_mfma_f32_16x16x32_bf16 v[72:75], a[124:127], v[24:27], v[72:75]
    ds_read_b64_tr_b16 v[46:47], v7 offset:47104
    v_mfma_f32_16x16x32_bf16 v[88:91], a[128:131], v[24:27], v[88:91]
    v_mfma_f32_16x16x32_bf16 v[100:103], a[240:243], v[16:19], v[100:103]
    buffer_load_dwordx4 a[116:119], v2, s[4:7], s90 offen offset:3072 sc1
    s_waitcnt lgkmcnt(8)
    v_mfma_f32_16x16x32_bf16 v[60:63], a[120:123], v[28:31], v[60:63]
    v_mfma_f32_16x16x32_bf16 v[76:79], a[124:127], v[28:31], v[76:79]
    v_mfma_f32_16x16x32_bf16 v[92:95], a[128:131], v[28:31], v[92:95]
    s_waitcnt lgkmcnt(6)
    v_mfma_f32_16x16x32_bf16 v[48:51], a[132:135], v[32:35], v[48:51]
    ds_read_b64_tr_b16 v[16:17], v4 offset:49152
    v_mfma_f32_16x16x32_bf16 v[64:67], a[136:139], v[32:35], v[64:67]
    ds_read_b64_tr_b16 v[18:19], v4 offset:51200
    v_mfma_f32_16x16x32_bf16 v[80:83], a[140:143], v[32:35], v[80:83]
    ds_read_b64_tr_b16 v[20:21], v5 offset:49152
    v_mfma_f32_16x16x32_bf16 v[96:99], v[32:35], v[32:35], v[96:99]
    s_waitcnt lgkmcnt(7)
    v_mfma_f32_16x16x32_bf16 v[52:55], a[132:135], v[36:39], v[52:55]
    ds_read_b64_tr_b16 v[22:23], v5 offset:51200
    v_mfma_f32_16x16x32_bf16 v[68:71], a[136:139], v[36:39], v[68:71]
    ds_read_b64_tr_b16 v[24:25], v6 offset:49152
    v_mfma_f32_16x16x32_bf16 v[84:87], a[140:143], v[36:39], v[84:87]
    ds_read_b64_tr_b16 v[26:27], v6 offset:51200
    s_waitcnt lgkmcnt(8)
    v_mfma_f32_16x16x32_bf16 v[56:59], a[132:135], v[40:43], v[56:59]
    ds_read_b64_tr_b16 v[28:29], v7 offset:49152
    v_mfma_f32_16x16x32_bf16 v[72:75], a[136:139], v[40:43], v[72:75]
    ds_read_b64_tr_b16 v[30:31], v7 offset:51200
    v_mfma_f32_16x16x32_bf16 v[88:91], a[140:143], v[40:43], v[88:91]
    v_mfma_f32_16x16x32_bf16 v[100:103], a[240:243], v[32:35], v[100:103]
    buffer_load_dword v119, v122, s[4:7], s86 offen sc1
    s_waitcnt lgkmcnt(8)
    v_mfma_f32_16x16x32_bf16 v[60:63], a[132:135], v[44:47], v[60:63]
    v_mfma_f32_16x16x32_bf16 v[76:79], a[136:139], v[44:47], v[76:79]
    v_mfma_f32_16x16x32_bf16 v[92:95], a[140:143], v[44:47], v[92:95]
    s_waitcnt lgkmcnt(6)
    v_mfma_f32_16x16x32_bf16 v[48:51], a[144:147], v[16:19], v[48:51]
    ds_read_b64_tr_b16 v[32:33], v4 offset:53248
    v_mfma_f32_16x16x32_bf16 v[64:67], a[148:151], v[16:19], v[64:67]
    ds_read_b64_tr_b16 v[34:35], v4 offset:55296
    v_mfma_f32_16x16x32_bf16 v[80:83], a[152:155], v[16:19], v[80:83]
    ds_read_b64_tr_b16 v[36:37], v5 offset:53248
    v_mfma_f32_16x16x32_bf16 v[96:99], v[16:19], v[16:19], v[96:99]
    s_waitcnt lgkmcnt(7)
    v_mfma_f32_16x16x32_bf16 v[52:55], a[144:147], v[20:23], v[52:55]
    ds_read_b64_tr_b16 v[38:39], v5 offset:55296
    v_mfma_f32_16x16x32_bf16 v[68:71], a[148:151], v[20:23], v[68:71]
    ds_read_b64_tr_b16 v[40:41], v6 offset:53248
    v_mfma_f32_16x16x32_bf16 v[84:87], a[152:155], v[20:23], v[84:87]
    ds_read_b64_tr_b16 v[42:43], v6 offset:55296
    s_waitcnt lgkmcnt(8)
    v_mfma_f32_16x16x32_bf16 v[56:59], a[144:147], v[24:27], v[56:59]
    ds_read_b64_tr_b16 v[44:45], v7 offset:53248
    v_mfma_f32_16x16x32_bf16 v[72:75], a[148:151], v[24:27], v[72:75]
    ds_read_b64_tr_b16 v[46:47], v7 offset:55296
    v_mfma_f32_16x16x32_bf16 v[88:91], a[152:155], v[24:27], v[88:91]
    v_mfma_f32_16x16x32_bf16 v[100:103], a[240:243], v[16:19], v[100:103]
    s_waitcnt lgkmcnt(8)
    v_mfma_f32_16x16x32_bf16 v[60:63], a[144:147], v[28:31], v[60:63]
    v_mfma_f32_16x16x32_bf16 v[76:79], a[148:151], v[28:31], v[76:79]
    v_mfma_f32_16x16x32_bf16 v[92:95], a[152:155], v[28:31], v[92:95]
    s_waitcnt lgkmcnt(6)
    v_mfma_f32_16x16x32_bf16 v[48:51], a[156:159], v[32:35], v[48:51]
    ds_read_b64_tr_b16 v[16:17], v4 offset:57344
    v_mfma_f32_16x16x32_bf16 v[64:67], a[160:163], v[32:35], v[64:67]
    ds_read_b64_tr_b16 v[18:19], v4 offset:59392
    v_mfma_f32_16x16x32_bf16 v[80:83], a[164:167], v[32:35], v[80:83]
    ds_read_b64_tr_b16 v[20:21], v5 offset:57344
    v_mfma_f32_16x16x32_bf16 v[96:99], v[32:35], v[32:35], v[96:99]
    s_waitcnt lgkmcnt(7)
    v_mfma_f32_16x16x32_bf16 v[52:55], a[156:159], v[36:39], v[52:55]
    ds_read_b64_tr_b16 v[22:23], v5 offset:59392
    v_mfma_f32_16x16x32_bf16 v[68:71], a[160:163], v[36:39], v[68:71]
    ds_read_b64_tr_b16 v[24:25], v6 offset:57344
    v_mfma_f32_16x16x32_bf16 v[84:87], a[164:167], v[36:39], v[84:87]
    ds_read_b64_tr_b16 v[26:27], v6 offset:59392
    s_waitcnt lgkmcnt(8)
    v_mfma_f32_16x16x32_bf16 v[56:59], a[156:159], v[40:43], v[56:59]
    ds_read_b64_tr_b16 v[28:29], v7 offset:57344
    v_mfma_f32_16x16x32_bf16 v[72:75], a[160:163], v[40:43], v[72:75]
    ds_read_b64_tr_b16 v[30:31], v7 offset:59392
    v_mfma_f32_16x16x32_bf16 v[88:91], a[164:167], v[40:43], v[88:91]
    v_mfma_f32_16x16x32_bf16 v[100:103], a[240:243], v[32:35], v[100:103]
    s_waitcnt vmcnt(0)
    v_cmp_ne_u32 vcc, s28, v119
    s_waitcnt lgkmcnt(8)
    v_mfma_f32_16x16x32_bf16 v[60:63], a[156:159], v[44:47], v[60:63]
    v_mfma_f32_16x16x32_bf16 v[76:79], a[160:163], v[44:47], v[76:79]
    v_mfma_f32_16x16x32_bf16 v[92:95], a[164:167], v[44:47], v[92:95]
    s_cbranch_vccnz gp_kernel_HEs
gp_kernel_HEd:
    s_barrier
    s_waitcnt lgkmcnt(6)
    v_mfma_f32_16x16x32_bf16 v[48:51], a[168:171], v[16:19], v[48:51]
    ds_read_b64_tr_b16 v[32:33], v4 offset:61440
    v_mfma_f32_16x16x32_bf16 v[64:67], a[172:175], v[16:19], v[64:67]
    ds_read_b64_tr_b16 v[34:35], v4 offset:63488
    s_add_u32 s34, s89, 0
    buffer_load_dwordx4 a[120:123], v2, s[4:7], s34 offen offset:0 sc1
    v_mfma_f32_16x16x32_bf16 v[80:83], a[176:179], v[16:19], v[80:83]
    ds_read_b64_tr_b16 v[36:37], v5 offset:61440
    v_mfma_f32_16x16x32_bf16 v[96:99], v[16:19], v[16:19], v[96:99]
    s_waitcnt lgkmcnt(7)
    v_mfma_f32_16x16x32_bf16 v[52:55], a[168:171], v[20:23], v[52:55]
    ds_read_b64_tr_b16 v[38:39], v5 offset:63488
    s_add_u32 s34, s89, 49152
    buffer_load_dwordx4 a[124:127], v2, s[4:7], s34 offen offset:0 sc1
    v_mfma_f32_16x16x32_bf16 v[68:71], a[172:175], v[20:23], v[68:71]
    ds_read_b64_tr_b16 v[40:41], v6 offset:61440
    v_mfma_f32_16x16x32_bf16 v[84:87], a[176:179], v[20:23], v[84:87]
    ds_read_b64_tr_b16 v[42:43], v6 offset:63488
    s_waitcnt lgkmcnt(8)
    v_mfma_f32_16x16x32_bf16 v[56:59], a[168:171], v[24:27], v[56:59]
    ds_read_b64_tr_b16 v[44:45], v7 offset:61440
    s_add_u32 s34, s89, 0
    buffer_load_dwordx4 a[128:131], v2, s[4:7], s34 offen offset:1024 sc1
    v_mfma_f32_16x16x32_bf16 v[72:75], a[172:175], v[24:27], v[72:75]
    ds_read_b64_tr_b16 v[46:47], v7 offset:63488
    v_mfma_f32_16x16x32_bf16 v[88:91], a[176:179], v[24:27], v[88:91]
    v_mfma_f32_16x16x32_bf16 v[100:103], a[240:243], v[16:19], v[100:103]
    s_waitcnt lgkmcnt(8)
    v_mfma_f32_16x16x32_bf16 v[60:63], a[168:171], v[28:31], v[60:63]
    s_add_u32 s34, s89, 49152
    buffer_load_dwordx4 a[132:135], v2, s[4:7], s34 offen offset:1024 sc1
    v_mfma_f32_16x16x32_bf16 v[76:79], a[172:175], v[28:31], v[76:79]
    v_mfma_f32_16x16x32_bf16 v[92:95], a[176:179], v[28:31], v[92:95]
    v_add_u32 v4, 0x10000, v4
    v_add_u32 v5, 0x10000, v5
    v_add_u32 v6, 0x10000, v6
    v_add_u32 v7, 0x10000, v7
    s_waitcnt lgkmcnt(6)
    v_mfma_f32_16x16x32_bf16 v[48:51], a[180:183], v[32:35], v[48:51]
    ds_read_b64_tr_b16 v[16:17], v4 offset:0
    v_mfma_f32_16x16x32_bf16 v[64:67], a[184:187], v[32:35], v[64:67]
    ds_read_b64_tr_b16 v[18:19], v4 offset:2048
    s_add_u32 s34, s89, 0
    buffer_load_dwordx4 a[136:139], v2, s[4:7], s34 offen offset:2048 sc1
    v_mfma_f32_16x16x32_bf16 v[80:83], a[188:191], v[32:35], v[80:83]
    ds_read_b64_tr_b16 v[20:21], v5 offset:0
    v_mfma_f32_16x16x32_bf16 v[96:99], v[32:35], v[32:35], v[96:99]
    s_waitcnt lgkmcnt(7)
    v_mfma_f32_16x16x32_bf16 v[52:55], a[180:183], v[36:39], v[52:55]
    ds_read_b64_tr_b16 v[22:23], v5 offset:2048
    s_add_u32 s34, s89, 49152
    buffer_load_dwordx4 a[140:143], v2, s[4:7], s34 offen offset:2048 sc1
    v_mfma_f32_16x16x32_bf16 v[68:71], a[184:187], v[36:39], v[68:71]
    ds_read_b64_tr_b16 v[24:25], v6 offset:0
    v_mfma_f32_16x16x32_bf16 v[84:87], a[188:191], v[36:39], v[84:87]
    ds_read_b64_tr_b16 v[26:27], v6 offset:2048
    s_waitcnt lgkmcnt(8)
    v_mfma_f32_16x16x32_bf16 v[56:59], a[180:183], v[40:43], v[56:59]
    ds_read_b64_tr_b16 v[28:29], v7 offset:0
    s_add_u32 s34, s89, 0
    buffer_load_dwordx4 a[144:147], v2, s[4:7], s34 offen offset:3072 sc1
    v_mfma_f32_16x16x32_bf16 v[72:75], a[184:187], v[40:43], v[72:75]
    ds_read_b64_tr_b16 v[30:31], v7 offset:2048
    v_mfma_f32_16x16x32_bf16 v[88:91], a[188:191], v[40:43], v[88:91]
    v_mfma_f32_16x16x32_bf16 v[100:103], a[240:243], v[32:35], v[100:103]
    s_waitcnt lgkmcnt(8)
    v_mfma_f32_16x16x32_bf16 v[60:63], a[180:183], v[44:47], v[60:63]
    s_add_u32 s34, s89, 49152
    buffer_load_dwordx4 a[148:151], v2, s[4:7], s34 offen offset:3072 sc1
    v_mfma_f32_16x16x32_bf16 v[76:79], a[184:187], v[44:47], v[76:79]
    v_mfma_f32_16x16x32_bf16 v[92:95], a[188:191], v[44:47], v[92:95]
    s_waitcnt lgkmcnt(6)
    v_mfma_f32_16x16x32_bf16 v[48:51], a[192:195], v[16:19], v[48:51]
    ds_read_b64_tr_b16 v[32:33], v4 offset:4096
    v_mfma_f32_16x16x32_bf16 v[64:67], a[196:199], v[16:19], v[64:67]
    ds_read_b64_tr_b16 v[34:35], v4 offset:6144
    s_add_u32 s34, s89, 4096
    buffer_load_dwordx4 a[152:155], v2, s[4:7], s34 offen offset:0 sc1
    v_mfma_f32_16x16x32_bf16 v[80:83], a[200:203], v[16:19], v[80:83]
    ds_read_b64_tr_b16 v[36:37], v5 offset:4096
    v_mfma_f32_16x16x32_bf16 v[96:99], v[16:19], v[16:19], v[96:99]
    s_waitcnt lgkmcnt(7)
    v_mfma_f32_16x16x32_bf16 v[52:55], a[192:195], v[20:23], v[52:55]
    ds_read_b64_tr_b16 v[38:39], v5 offset:6144
    s_add_u32 s34, s89, 53248
    buffer_load_dwordx4 a[156:159], v2, s[4:7], s34 offen offset:0 sc1
    v_mfma_f32_16x16x32_bf16 v[68:71], a[196:199], v[20:23], v[68:71]
    ds_read_b64_tr_b16 v[40:41], v6 offset:4096
    v_mfma_f32_16x16x32_bf16 v[84:87], a[200:203], v[20:23], v[84:87]
    ds_read_b64_tr_b16 v[42:43], v6 offset:6144
    s_waitcnt lgkmcnt(8)
    v_mfma_f32_16x16x32_bf16 v[56:59], a[192:195], v[24:27], v[56:59]
    ds_read_b64_tr_b16 v[44:45], v7 offset:4096
    s_add_u32 s34, s89, 4096
    buffer_load_dwordx4 a[160:163], v2, s[4:7], s34 offen offset:1024 sc1
    v_mfma_f32_16x16x32_bf16 v[72:75], a[196:199], v[24:27], v[72:75]
    ds_read_b64_tr_b16 v[46:47], v7 offset:6144
    v_mfma_f32_16x16x32_bf16 v[88:91], a[200:203], v[24:27], v[88:91]
    v_mfma_f32_16x16x32_bf16 v[100:103], a[240:243], v[16:19], v[100:103]
    s_waitcnt lgkmcnt(8)
    v_mfma_f32_16x16x32_bf16 v[60:63], a[192:195], v[28:31], v[60:63]
    s_add_u32 s34, s89, 53248
    buffer_load_dwordx4 a[164:167], v2, s[4:7], s34 offen offset:1024 sc1
    v_mfma_f32_16x16x32_bf16 v[76:79], a[196:199], v[28:31], v[76:79]
    v_mfma_f32_16x16x32_bf16 v[92:95], a[200:203], v[28:31], v[92:95]
    s_waitcnt lgkmcnt(6)
    v_mfma_f32_16x16x32_bf16 v[48:51], a[204:207], v[32:35], v[48:51]
    ds_read_b64_tr_b16 v[16:17], v4 offset:8192
    v_mfma_f32_16x16x32_bf16 v[64:67], a[208:211], v[32:35], v[64:67]
    ds_read_b64_tr_b16 v[18:19], v4 offset:10240
    s_add_u32 s34, s89, 4096
    buffer_load_dwordx4 a[168:171], v2, s[4:7], s34 offen offset:2048 sc1
    v_mfma_f32_16x16x32_bf16 v[80:83], a[212:215], v[32:35], v[80:83]
    ds_read_b64_tr_b16 v[20:21], v5 offset:8192
    v_mfma_f32_16x16x32_bf16 v[96:99], v[32:35], v[32:35], v[96:99]
    s_waitcnt lgkmcnt(7)
    v_mfma_f32_16x16x32_bf16 v[52:55], a[204:207], v[36:39], v[52:55]
    ds_read_b64_tr_b16 v[22:23], v5 offset:10240
    s_add_u32 s34, s89, 53248
    buffer_load_dwordx4 a[172:175], v2, s[4:7], s34 offen offset:2048 sc1
    v_mfma_f32_16x16x32_bf16 v[68:71], a[208:211], v[36:39], v[68:71]
    ds_read_b64_tr_b16 v[24:25], v6 offset:8192
    v_mfma_f32_16x16x32_bf16 v[84:87], a[212:215], v[36:39], v[84:87]
    ds_read_b64_tr_b16 v[26:27], v6 offset:10240
    s_waitcnt lgkmcnt(8)
    v_mfma_f32_16x16x32_bf16 v[56:59], a[204:207], v[40:43], v[56:59]
    ds_read_b64_tr_b16 v[28:29], v7 offset:8192
    s_add_u32 s34, s89, 4096
    buffer_load_dwordx4 a[176:179], v2, s[4:7], s34 offen offset:3072 sc1
    v_mfma_f32_16x16x32_bf16 v[72:75], a[208:211], v[40:43], v[72:75]
    ds_read_b64_tr_b16 v[30:31], v7 offset:10240
    v_mfma_f32_16x16x32_bf16 v[88:91], a[212:215], v[40:43], v[88:91]
    v_mfma_f32_16x16x32_bf16 v[100:103], a[240:243], v[32:35], v[100:103]
    s_waitcnt lgkmcnt(8)
    v_mfma_f32_16x16x32_bf16 v[60:63], a[204:207], v[44:47], v[60:63]
    s_add_u32 s34, s89, 53248
    buffer_load_dwordx4 a[180:183], v2, s[4:7], s34 offen offset:3072 sc1
    v_mfma_f32_16x16x32_bf16 v[76:79], a[208:211], v[44:47], v[76:79]
    v_mfma_f32_16x16x32_bf16 v[92:95], a[212:215], v[44:47], v[92:95]
    s_waitcnt lgkmcnt(6)
    v_mfma_f32_16x16x32_bf16 v[48:51], a[216:219], v[16:19], v[48:51]
    ds_read_b64_tr_b16 v[32:33], v4 offset:12288
    v_mfma_f32_16x16x32_bf16 v[64:67], a[220:223], v[16:19], v[64:67]
    ds_read_b64_tr_b16 v[34:35], v4 offset:14336
    s_add_u32 s34, s89, 8192
    buffer_load_dwordx4 a[184:187], v2, s[4:7], s34 offen offset:0 sc1
    v_mfma_f32_16x16x32_bf16 v[80:83], a[224:227], v[16:19], v[80:83]
    ds_read_b64_tr_b16 v[36:37], v5 offset:12288
    v_mfma_f32_16x16x32_bf16 v[96:99], v[16:19], v[16:19], v[96:99]
    s_waitcnt lgkmcnt(7)
    v_mfma_f32_16x16x32_bf16 v[52:55], a[216:219], v[20:23], v[52:55]
    ds_read_b64_tr_b16 v[38:39], v5 offset:14336
    s_add_u32 s34, s89, 57344
    buffer_load_dwordx4 a[188:191], v2, s[4:7], s34 offen offset:0 sc1
    v_mfma_f32_16x16x32_bf16 v[68:71], a[220:223], v[20:23], v[68:71]
    ds_read_b64_tr_b16 v[40:41], v6 offset:12288
    v_mfma_f32_16x16x32_bf16 v[84:87], a[224:227], v[20:23], v[84:87]
    ds_read_b64_tr_b16 v[42:43], v6 offset:14336
    s_waitcnt lgkmcnt(8)
    v_mfma_f32_16x16x32_bf16 v[56:59], a[216:219], v[24:27], v[56:59]
    ds_read_b64_tr_b16 v[44:45], v7 offset:12288
    s_add_u32 s34, s89, 8192
    buffer_load_dwordx4 a[192:195], v2, s[4:7], s34 offen offset:1024 sc1
    v_mfma_f32_16x16x32_bf16 v[72:75], a[220:223], v[24:27], v[72:75]
    ds_read_b64_tr_b16 v[46:47], v7 offset:14336
    v_mfma_f32_16x16x32_bf16 v[88:91], a[224:227], v[24:27], v[88:91]
    v_mfma_f32_16x16x32_bf16 v[100:103], a[240:243], v[16:19], v[100:103]
    s_waitcnt lgkmcnt(8)
    v_mfma_f32_16x16x32_bf16 v[60:63], a[216:219], v[28:31], v[60:63]
    s_add_u32 s34, s89, 57344
    buffer_load_dwordx4 a[196:199], v2, s[4:7], s34 offen offset:1024 sc1
    v_mfma_f32_16x16x32_bf16 v[76:79], a[220:223], v[28:31], v[76:79]
    v_mfma_f32_16x16x32_bf16 v[92:95], a[224:227], v[28:31], v[92:95]
    s_waitcnt lgkmcnt(6)
    v_mfma_f32_16x16x32_bf16 v[48:51], a[228:231], v[32:35], v[48:51]
    v_mfma_f32_16x16x32_bf16 v[96:99], v[32:35], v[32:35], v[96:99]
    v_mfma_f32_16x16x32_bf16 v[100:103], a[240:243], v[32:35], v[100:103]
    v_mfma_f32_16x16x32_bf16 v[64:67], a[232:235], v[32:35], v[64:67]
    s_add_u32 s34, s89, 8192
    buffer_load_dwordx4 a[200:203], v2, s[4:7], s34 offen offset:2048 sc1
    v_mfma_f32_16x16x32_bf16 v[80:83], a[236:239], v[32:35], v[80:83]
    s_waitcnt lgkmcnt(4)
    v_mfma_f32_16x16x32_bf16 v[52:55], a[228:231], v[36:39], v[52:55]
    s_add_u32 s34, s89, 57344
    buffer_load_dwordx4 a[204:207], v2, s[4:7], s34 offen offset:2048 sc1
    v_mfma_f32_16x16x32_bf16 v[68:71], a[232:235], v[36:39], v[68:71]
    v_mfma_f32_16x16x32_bf16 v[84:87], a[236:239], v[36:39], v[84:87]
    s_waitcnt lgkmcnt(2)
    v_mfma_f32_16x16x32_bf16 v[56:59], a[228:231], v[40:43], v[56:59]
    s_add_u32 s34, s89, 8192
    buffer_load_dwordx4 a[208:211], v2, s[4:7], s34 offen offset:3072 sc1
    v_mfma_f32_16x16x32_bf16 v[72:75], a[232:235], v[40:43], v[72:75]
    v_cndmask_b32 v96, v96, v97, s[80:81]
    v_cndmask_b32 v98, v98, v99, s[80:81]
    v_mfma_f32_16x16x32_bf16 v[88:91], a[236:239], v[40:43], v[88:91]
    v_cndmask_b32 v97, v96, v98, s[60:61]
    v_mul_f32 v96, -0.0015625, v100
    s_waitcnt lgkmcnt(0)
    v_mfma_f32_16x16x32_bf16 v[60:63], a[228:231], v[44:47], v[60:63]
    v_mul_f32 v97, 0.0015625, v97
    v_fma_f32 v97, -v96, v96, v97
    s_add_u32 s34, s89, 57344
    buffer_load_dwordx4 a[212:215], v2, s[4:7], s34 offen offset:3072 sc1
    v_mfma_f32_16x16x32_bf16 v[76:79], a[232:235], v[44:47], v[76:79]
    v_max_f32 v97, 0, v97
    v_add_f32 v97, 1e-05, v97
    v_mfma_f32_16x16x32_bf16 v[92:95], a[236:239], v[44:47], v[92:95]
    v_rcp_f32 v97, v97
    s_mov_b64 exec, s[62:63]
    ds_write2_b64 v14, v[96:97], v[96:97] offset0:0 offset1:64
    s_mov_b64 exec, -1
    s_waitcnt lgkmcnt(0)
    s_barrier
    ds_read_b64 v[104:105], v14 offset:0
    ds_read_b64 v[106:107], v14 offset:128
    ds_read_b64 v[108:109], v14 offset:256
    ds_read_b64 v[110:111], v14 offset:384
    s_waitcnt lgkmcnt(3)
    v_pk_fma_f32 v[48:49], v[244:245], v[104:105], v[48:49] op_sel_hi:[1,0,1]
    v_pk_fma_f32 v[50:51], v[246:247], v[104:105], v[50:51] op_sel_hi:[1,0,1]
    v_pk_fma_f32 v[64:65], v[248:249], v[104:105], v[64:65] op_sel_hi:[1,0,1]
    v_pk_fma_f32 v[66:67], v[250:251], v[104:105], v[66:67] op_sel_hi:[1,0,1]
    v_pk_fma_f32 v[80:81], v[252:253], v[104:105], v[80:81] op_sel_hi:[1,0,1]
    v_pk_fma_f32 v[82:83], v[254:255], v[104:105], v[82:83] op_sel_hi:[1,0,1]
    s_waitcnt lgkmcnt(2)
    v_pk_fma_f32 v[52:53], v[244:245], v[106:107], v[52:53] op_sel_hi:[1,0,1]
    v_pk_fma_f32 v[54:55], v[246:247], v[106:107], v[54:55] op_sel_hi:[1,0,1]
    v_pk_fma_f32 v[68:69], v[248:249], v[106:107], v[68:69] op_sel_hi:[1,0,1]
    v_pk_fma_f32 v[70:71], v[250:251], v[106:107], v[70:71] op_sel_hi:[1,0,1]
    v_pk_fma_f32 v[84:85], v[252:253], v[106:107], v[84:85] op_sel_hi:[1,0,1]
    v_pk_fma_f32 v[86:87], v[254:255], v[106:107], v[86:87] op_sel_hi:[1,0,1]
    s_waitcnt lgkmcnt(1)
    v_pk_fma_f32 v[56:57], v[244:245], v[108:109], v[56:57] op_sel_hi:[1,0,1]
    v_pk_fma_f32 v[58:59], v[246:247], v[108:109], v[58:59] op_sel_hi:[1,0,1]
    v_pk_fma_f32 v[72:73], v[248:249], v[108:109], v[72:73] op_sel_hi:[1,0,1]
    v_pk_fma_f32 v[74:75], v[250:251], v[108:109], v[74:75] op_sel_hi:[1,0,1]
    v_pk_fma_f32 v[88:89], v[252:253], v[108:109], v[88:89] op_sel_hi:[1,0,1]
    v_pk_fma_f32 v[90:91], v[254:255], v[108:109], v[90:91] op_sel_hi:[1,0,1]
    s_waitcnt lgkmcnt(0)
    v_pk_fma_f32 v[60:61], v[244:245], v[110:111], v[60:61] op_sel_hi:[1,0,1]
    v_pk_fma_f32 v[62:63], v[246:247], v[110:111], v[62:63] op_sel_hi:[1,0,1]
    v_pk_fma_f32 v[76:77], v[248:249], v[110:111], v[76:77] op_sel_hi:[1,0,1]
    v_pk_fma_f32 v[78:79], v[250:251], v[110:111], v[78:79] op_sel_hi:[1,0,1]
    v_pk_fma_f32 v[92:93], v[252:253], v[110:111], v[92:93] op_sel_hi:[1,0,1]
    v_pk_fma_f32 v[94:95], v[254:255], v[110:111], v[94:95] op_sel_hi:[1,0,1]
    v_cndmask_b32 v118, v107, v105, s[82:83]
    v_cndmask_b32 v120, v111, v109, s[82:83]
    v_pk_mul_f32 v[48:49], v[48:49], v[64:65]
    v_pk_mul_f32 v[50:51], v[50:51], v[66:67]
    v_pk_mul_f32 v[52:53], v[52:53], v[68:69]
    v_pk_mul_f32 v[54:55], v[54:55], v[70:71]
    v_permlane32_swap_b32 v80, v84
    v_permlane32_swap_b32 v81, v85
    v_permlane32_swap_b32 v82, v86
    v_permlane32_swap_b32 v83, v87
    v_pk_mul_f32 v[48:49], v[48:49], v[104:105] op_sel:[0,1] op_sel_hi:[1,1]
    v_pk_mul_f32 v[50:51], v[50:51], v[104:105] op_sel:[0,1] op_sel_hi:[1,1]
    v_pk_mul_f32 v[52:53], v[52:53], v[106:107] op_sel:[0,1] op_sel_hi:[1,1]
    v_pk_mul_f32 v[54:55], v[54:55], v[106:107] op_sel:[0,1] op_sel_hi:[1,1]
    v_pk_mul_f32 v[80:81], v[80:81], v[84:85]
    v_pk_mul_f32 v[82:83], v[82:83], v[86:87]
    v_cvt_pk_bf16_f32 v32, v48, v49
    v_cvt_pk_bf16_f32 v33, v50, v51
    v_cvt_pk_bf16_f32 v34, v52, v53
    v_cvt_pk_bf16_f32 v35, v54, v55
    v_pk_mul_f32 v[80:81], v[80:81], v[118:119] op_sel_hi:[1,0]
    v_pk_mul_f32 v[82:83], v[82:83], v[118:119] op_sel_hi:[1,0]
    v_permlane16_swap_b32 v32, v34
    v_permlane16_swap_b32 v33, v35
    v_cvt_pk_bf16_f32 v40, v80, v81
    v_cvt_pk_bf16_f32 v41, v82, v83
    buffer_store_dwordx4 v[32:35], v8, s[4:7], s94 offen sc1
    v_pk_mul_f32 v[56:57], v[56:57], v[72:73]
    v_pk_mul_f32 v[58:59], v[58:59], v[74:75]
    v_pk_mul_f32 v[60:61], v[60:61], v[76:77]
    v_pk_mul_f32 v[62:63], v[62:63], v[78:79]
    v_permlane32_swap_b32 v88, v92
    v_permlane32_swap_b32 v89, v93
    v_permlane32_swap_b32 v90, v94
    v_permlane32_swap_b32 v91, v95
    v_pk_mul_f32 v[56:57], v[56:57], v[108:109] op_sel:[0,1] op_sel_hi:[1,1]
    v_pk_mul_f32 v[58:59], v[58:59], v[108:109] op_sel:[0,1] op_sel_hi:[1,1]
    v_pk_mul_f32 v[60:61], v[60:61], v[110:111] op_sel:[0,1] op_sel_hi:[1,1]
    v_pk_mul_f32 v[62:63], v[62:63], v[110:111] op_sel:[0,1] op_sel_hi:[1,1]
    v_pk_mul_f32 v[88:89], v[88:89], v[92:93]
    v_pk_mul_f32 v[90:91], v[90:91], v[94:95]
    v_cvt_pk_bf16_f32 v36, v56, v57
    v_cvt_pk_bf16_f32 v37, v58, v59
    v_cvt_pk_bf16_f32 v38, v60, v61
    v_cvt_pk_bf16_f32 v39, v62, v63
    v_pk_mul_f32 v[88:89], v[88:89], v[120:121] op_sel_hi:[1,0]
    v_pk_mul_f32 v[90:91], v[90:91], v[120:121] op_sel_hi:[1,0]
    v_permlane16_swap_b32 v36, v38
    v_permlane16_swap_b32 v37, v39
    v_cvt_pk_bf16_f32 v42, v88, v89
    v_cvt_pk_bf16_f32 v43, v90, v91
    buffer_store_dwordx4 v[36:39], v9, s[4:7], s94 offen sc1
    s_nop 0
    v_permlane16_swap_b32 v40, v42
    v_permlane16_swap_b32 v41, v43
    buffer_store_dwordx4 v[40:43], v10, s[4:7], s94 offen offset:512 sc1
    s_waitcnt vmcnt(26)
    v_mfma_f32_16x16x32_bf16 v[16:19], v[124:127], a[120:123], 0
    s_mul_i32 s34, s3, 10240
    v_mfma_f32_16x16x32_bf16 v[20:23], v[128:131], a[120:123], 0
    s_add_u32 s34, s34, 0
    v_mfma_f32_16x16x32_bf16 v[24:27], v[132:135], a[120:123], 0
    v_add_u32 v4, s34, v2
    v_mfma_f32_16x16x32_bf16 v[28:31], v[136:139], a[120:123], 0
    s_lshr_b32 s34, s3, 1
    v_mfma_f32_16x16x32_bf16 v[32:35], v[140:143], a[120:123], 0
    s_mul_i32 s34, s34, 5
    s_waitcnt vmcnt(25)
    v_mfma_f32_16x16x32_bf16 v[36:39], v[124:127], a[124:127], 0
    s_and_b32 s35, s3, 1
    v_mfma_f32_16x16x32_bf16 v[40:43], v[128:131], a[124:127], 0
    s_lshl_b32 s35, s35, 1
    v_mfma_f32_16x16x32_bf16 v[44:47], v[132:135], a[124:127], 0
    s_add_u32 s34, s34, s35
    v_mfma_f32_16x16x32_bf16 v[48:51], v[136:139], a[124:127], 0
    s_lshl_b32 s34, s34, 10
    v_mfma_f32_16x16x32_bf16 v[52:55], v[140:143], a[124:127], 0
    s_add_u32 s34, s34, 0
    s_waitcnt vmcnt(24)
    v_mfma_f32_16x16x32_bf16 v[16:19], v[144:147], a[128:131], v[16:19]
    v_add_u32 v5, s34, v2
    v_mfma_f32_16x16x32_bf16 v[20:23], v[148:151], a[128:131], v[20:23]
    v_add_u32 v6, 40960, v5
    v_mfma_f32_16x16x32_bf16 v[24:27], v[152:155], a[128:131], v[24:27]
    v_add_u32 v12, s97, v12
    v_mfma_f32_16x16x32_bf16 v[28:31], v[156:159], a[128:131], v[28:31]
    v_add_u32 v13, s97, v13
    v_mfma_f32_16x16x32_bf16 v[32:35], v[160:163], a[128:131], v[32:35]
    s_add_u32 s85, s85, 65536
    s_waitcnt vmcnt(23)
    v_mfma_f32_16x16x32_bf16 v[36:39], v[144:147], a[132:135], v[36:39]
    s_add_u32 s86, s86, 65536
    v_mfma_f32_16x16x32_bf16 v[40:43], v[148:151], a[132:135], v[40:43]
    v_mfma_f32_16x16x32_bf16 v[44:47], v[152:155], a[132:135], v[44:47]
    v_mfma_f32_16x16x32_bf16 v[48:51], v[156:159], a[132:135], v[48:51]
    v_mfma_f32_16x16x32_bf16 v[52:55], v[160:163], a[132:135], v[52:55]
    s_waitcnt vmcnt(22)
    v_mfma_f32_16x16x32_bf16 v[16:19], v[164:167], a[136:139], v[16:19]
    v_mfma_f32_16x16x32_bf16 v[20:23], v[168:171], a[136:139], v[20:23]
    v_mfma_f32_16x16x32_bf16 v[24:27], v[172:175], a[136:139], v[24:27]
    v_mfma_f32_16x16x32_bf16 v[28:31], v[176:179], a[136:139], v[28:31]
    v_mfma_f32_16x16x32_bf16 v[32:35], v[180:183], a[136:139], v[32:35]
    s_waitcnt vmcnt(21)
    v_mfma_f32_16x16x32_bf16 v[36:39], v[164:167], a[140:143], v[36:39]
    v_mfma_f32_16x16x32_bf16 v[40:43], v[168:171], a[140:143], v[40:43]
    v_mfma_f32_16x16x32_bf16 v[44:47], v[172:175], a[140:143], v[44:47]
    v_mfma_f32_16x16x32_bf16 v[48:51], v[176:179], a[140:143], v[48:51]
    v_mfma_f32_16x16x32_bf16 v[52:55], v[180:183], a[140:143], v[52:55]
    s_waitcnt vmcnt(20)
    v_mfma_f32_16x16x32_bf16 v[16:19], v[184:187], a[144:147], v[16:19]
    v_mfma_f32_16x16x32_bf16 v[20:23], v[188:191], a[144:147], v[20:23]
    v_mfma_f32_16x16x32_bf16 v[24:27], v[192:195], a[144:147], v[24:27]
    v_mfma_f32_16x16x32_bf16 v[28:31], v[196:199], a[144:147], v[28:31]
    v_mfma_f32_16x16x32_bf16 v[32:35], v[200:203], a[144:147], v[32:35]
    s_waitcnt vmcnt(19)
    v_mfma_f32_16x16x32_bf16 v[36:39], v[184:187], a[148:151], v[36:39]
    v_mfma_f32_16x16x32_bf16 v[40:43], v[188:191], a[148:151], v[40:43]
    v_mfma_f32_16x16x32_bf16 v[44:47], v[192:195], a[148:151], v[44:47]
    v_mfma_f32_16x16x32_bf16 v[48:51], v[196:199], a[148:151], v[48:51]
    v_mfma_f32_16x16x32_bf16 v[52:55], v[200:203], a[148:151], v[52:55]
    s_waitcnt vmcnt(0)
    s_mov_b64 exec, 1
    buffer_store_dword v0, v15, s[4:7], s85 offen sc1
    s_mov_b64 exec, -1
    v_mfma_f32_16x16x32_bf16 v[16:19], v[204:207], a[152:155], v[16:19]
    v_mfma_f32_16x16x32_bf16 v[20:23], v[208:211], a[152:155], v[20:23]
    v_mfma_f32_16x16x32_bf16 v[24:27], v[212:215], a[152:155], v[24:27]
    v_mfma_f32_16x16x32_bf16 v[28:31], v[216:219], a[152:155], v[28:31]
    v_mfma_f32_16x16x32_bf16 v[32:35], v[220:223], a[152:155], v[32:35]
    v_mfma_f32_16x16x32_bf16 v[36:39], v[204:207], a[156:159], v[36:39]
    v_mfma_f32_16x16x32_bf16 v[40:43], v[208:211], a[156:159], v[40:43]
    v_mfma_f32_16x16x32_bf16 v[44:47], v[212:215], a[156:159], v[44:47]
    v_mfma_f32_16x16x32_bf16 v[48:51], v[216:219], a[156:159], v[48:51]
    v_mfma_f32_16x16x32_bf16 v[52:55], v[220:223], a[156:159], v[52:55]
    v_mfma_f32_16x16x32_bf16 v[16:19], v[224:227], a[160:163], v[16:19]
    v_mfma_f32_16x16x32_bf16 v[20:23], v[228:231], a[160:163], v[20:23]
    v_mfma_f32_16x16x32_bf16 v[24:27], v[232:235], a[160:163], v[24:27]
    v_mfma_f32_16x16x32_bf16 v[28:31], v[236:239], a[160:163], v[28:31]
    v_mfma_f32_16x16x32_bf16 v[32:35], v[240:243], a[160:163], v[32:35]
    v_mfma_f32_16x16x32_bf16 v[36:39], v[224:227], a[164:167], v[36:39]
    v_mfma_f32_16x16x32_bf16 v[40:43], v[228:231], a[164:167], v[40:43]
    v_mfma_f32_16x16x32_bf16 v[44:47], v[232:235], a[164:167], v[44:47]
    v_mfma_f32_16x16x32_bf16 v[48:51], v[236:239], a[164:167], v[48:51]
    v_mfma_f32_16x16x32_bf16 v[52:55], v[240:243], a[164:167], v[52:55]
    v_mfma_f32_16x16x32_bf16 v[16:19], a[0:3], a[168:171], v[16:19]
    v_mfma_f32_16x16x32_bf16 v[20:23], a[4:7], a[168:171], v[20:23]
    v_mfma_f32_16x16x32_bf16 v[24:27], a[8:11], a[168:171], v[24:27]
    v_mfma_f32_16x16x32_bf16 v[28:31], a[12:15], a[168:171], v[28:31]
    v_mfma_f32_16x16x32_bf16 v[32:35], a[16:19], a[168:171], v[32:35]
    v_mfma_f32_16x16x32_bf16 v[36:39], a[0:3], a[172:175], v[36:39]
    v_mfma_f32_16x16x32_bf16 v[40:43], a[4:7], a[172:175], v[40:43]
    v_mfma_f32_16x16x32_bf16 v[44:47], a[8:11], a[172:175], v[44:47]
    v_mfma_f32_16x16x32_bf16 v[48:51], a[12:15], a[172:175], v[48:51]
    v_mfma_f32_16x16x32_bf16 v[52:55], a[16:19], a[172:175], v[52:55]
    v_mfma_f32_16x16x32_bf16 v[16:19], a[20:23], a[176:179], v[16:19]
    v_mfma_f32_16x16x32_bf16 v[20:23], a[24:27], a[176:179], v[20:23]
    v_mfma_f32_16x16x32_bf16 v[24:27], a[28:31], a[176:179], v[24:27]
    v_mfma_f32_16x16x32_bf16 v[28:31], a[32:35], a[176:179], v[28:31]
    v_mfma_f32_16x16x32_bf16 v[32:35], a[36:39], a[176:179], v[32:35]
    v_mfma_f32_16x16x32_bf16 v[36:39], a[20:23], a[180:183], v[36:39]
    v_mfma_f32_16x16x32_bf16 v[40:43], a[24:27], a[180:183], v[40:43]
    v_mfma_f32_16x16x32_bf16 v[44:47], a[28:31], a[180:183], v[44:47]
    v_mfma_f32_16x16x32_bf16 v[48:51], a[32:35], a[180:183], v[48:51]
    v_mfma_f32_16x16x32_bf16 v[52:55], a[36:39], a[180:183], v[52:55]
    v_mfma_f32_16x16x32_bf16 v[16:19], a[40:43], a[184:187], v[16:19]
    v_mfma_f32_16x16x32_bf16 v[20:23], a[44:47], a[184:187], v[20:23]
    v_mfma_f32_16x16x32_bf16 v[24:27], a[48:51], a[184:187], v[24:27]
    v_mfma_f32_16x16x32_bf16 v[28:31], a[52:55], a[184:187], v[28:31]
    v_mfma_f32_16x16x32_bf16 v[32:35], a[56:59], a[184:187], v[32:35]
    v_mfma_f32_16x16x32_bf16 v[36:39], a[40:43], a[188:191], v[36:39]
    v_mfma_f32_16x16x32_bf16 v[40:43], a[44:47], a[188:191], v[40:43]
    v_mfma_f32_16x16x32_bf16 v[44:47], a[48:51], a[188:191], v[44:47]
    v_mfma_f32_16x16x32_bf16 v[48:51], a[52:55], a[188:191], v[48:51]
    v_mfma_f32_16x16x32_bf16 v[52:55], a[56:59], a[188:191], v[52:55]
    v_mfma_f32_16x16x32_bf16 v[16:19], a[60:63], a[192:195], v[16:19]
    v_mfma_f32_16x16x32_bf16 v[20:23], a[64:67], a[192:195], v[20:23]
    v_mfma_f32_16x16x32_bf16 v[24:27], a[68:71], a[192:195], v[24:27]
    v_mfma_f32_16x16x32_bf16 v[28:31], a[72:75], a[192:195], v[28:31]
    v_mfma_f32_16x16x32_bf16 v[32:35], a[76:79], a[192:195], v[32:35]
    v_mfma_f32_16x16x32_bf16 v[36:39], a[60:63], a[196:199], v[36:39]
    v_mfma_f32_16x16x32_bf16 v[40:43], a[64:67], a[196:199], v[40:43]
    v_mfma_f32_16x16x32_bf16 v[44:47], a[68:71], a[196:199], v[44:47]
    v_mfma_f32_16x16x32_bf16 v[48:51], a[72:75], a[196:199], v[48:51]
    v_mfma_f32_16x16x32_bf16 v[52:55], a[76:79], a[196:199], v[52:55]
    v_mfma_f32_16x16x32_bf16 v[16:19], a[80:83], a[200:203], v[16:19]
    v_mfma_f32_16x16x32_bf16 v[20:23], a[84:87], a[200:203], v[20:23]
    v_mfma_f32_16x16x32_bf16 v[24:27], a[88:91], a[200:203], v[24:27]
    v_mfma_f32_16x16x32_bf16 v[28:31], a[92:95], a[200:203], v[28:31]
    v_mfma_f32_16x16x32_bf16 v[32:35], a[96:99], a[200:203], v[32:35]
    v_mfma_f32_16x16x32_bf16 v[16:19], a[100:103], a[208:211], v[16:19]
    v_mfma_f32_16x16x32_bf16 v[20:23], a[104:107], a[208:211], v[20:23]
    v_mfma_f32_16x16x32_bf16 v[24:27], a[108:111], a[208:211], v[24:27]
    v_mfma_f32_16x16x32_bf16 v[28:31], a[112:115], a[208:211], v[28:31]
    v_mfma_f32_16x16x32_bf16 v[32:35], a[116:119], a[208:211], v[32:35]
    v_mfma_f32_16x16x32_bf16 v[36:39], a[80:83], a[204:207], v[36:39]
    v_mfma_f32_16x16x32_bf16 v[40:43], a[84:87], a[204:207], v[40:43]
    v_mfma_f32_16x16x32_bf16 v[44:47], a[88:91], a[204:207], v[44:47]
    v_mfma_f32_16x16x32_bf16 v[48:51], a[92:95], a[204:207], v[48:51]
    ds_write_b128 v4, v[16:19] offset:0
    v_mfma_f32_16x16x32_bf16 v[52:55], a[96:99], a[204:207], v[52:55]
    ds_write_b128 v4, v[20:23] offset:1024
    v_mfma_f32_16x16x32_bf16 v[36:39], a[100:103], a[212:215], v[36:39]
    ds_write_b128 v4, v[24:27] offset:2048
    v_mfma_f32_16x16x32_bf16 v[40:43], a[104:107], a[212:215], v[40:43]
    ds_write_b128 v4, v[28:31] offset:3072
    v_mfma_f32_16x16x32_bf16 v[44:47], a[108:111], a[212:215], v[44:47]
    ds_write_b128 v4, v[32:35] offset:4096
    v_mfma_f32_16x16x32_bf16 v[48:51], a[112:115], a[212:215], v[48:51]
    v_mfma_f32_16x16x32_bf16 v[52:55], a[116:119], a[212:215], v[52:55]
    s_nop 3
    ds_write_b128 v4, v[36:39] offset:5120
    ds_write_b128 v4, v[40:43] offset:6144
    ds_write_b128 v4, v[44:47] offset:7168
    ds_write_b128 v4, v[48:51] offset:8192
    ds_write_b128 v4, v[52:55] offset:9216
    buffer_load_dword v110, v122, s[4:7], s86 offen sc1
    s_waitcnt lgkmcnt(0)
    s_barrier
    ds_read_b128 v[56:59], v5 offset:0
    ds_read_b128 v[60:63], v5 offset:1024
    ds_read_b128 v[64:67], v5 offset:2048
    ds_read_b128 v[68:71], v5 offset:10240
    ds_read_b128 v[72:75], v5 offset:11264
    ds_read_b128 v[76:79], v5 offset:12288
    ds_read_b128 v[80:83], v5 offset:20480
    ds_read_b128 v[84:87], v5 offset:21504
    ds_read_b128 v[88:91], v5 offset:22528
    ds_read_b128 v[92:95], v5 offset:30720
    ds_read_b128 v[96:99], v5 offset:31744
    ds_read_b128 v[100:103], v5 offset:32768
    v_lshlrev_b32 v16, 16, v112
    v_and_b32 v17, s29, v112
    v_lshlrev_b32 v18, 16, v113
    v_and_b32 v19, s29, v113
    v_lshlrev_b32 v20, 16, v114
    v_and_b32 v21, s29, v114
    v_lshlrev_b32 v22, 16, v115
    v_and_b32 v23, s29, v115
    v_lshlrev_b32 v24, 16, v116
    v_and_b32 v25, s29, v116
    v_lshlrev_b32 v26, 16, v117
    v_and_b32 v27, s29, v117
    s_waitcnt vmcnt(0)
    v_cmp_ne_u32 vcc, s28, v110
    s_nop 4
    s_cbranch_vccnz gp_kernel_pHLs
    s_add_u32 s34, s89, 3145728
    buffer_load_dwordx4 a[120:123], v2, s[4:7], s34 offen offset:0 sc1
    s_add_u32 s34, s89, 3194880
    buffer_load_dwordx4 a[124:127], v2, s[4:7], s34 offen offset:0 sc1
    s_add_u32 s34, s89, 3145728
    buffer_load_dwordx4 a[128:131], v2, s[4:7], s34 offen offset:1024 sc1
    s_add_u32 s34, s89, 3194880
    buffer_load_dwordx4 a[132:135], v2, s[4:7], s34 offen offset:1024 sc1
    s_add_u32 s34, s89, 3145728
    buffer_load_dwordx4 a[136:139], v2, s[4:7], s34 offen offset:2048 sc1
    s_add_u32 s34, s89, 3194880
    buffer_load_dwordx4 a[140:143], v2, s[4:7], s34 offen offset:2048 sc1
    s_add_u32 s34, s89, 3145728
    buffer_load_dwordx4 a[144:147], v2, s[4:7], s34 offen offset:3072 sc1
    s_add_u32 s34, s89, 3194880
    buffer_load_dwordx4 a[148:151], v2, s[4:7], s34 offen offset:3072 sc1
    s_waitcnt lgkmcnt(9)
    v_pk_add_f32 v[16:17], v[16:17], v[56:57]
    v_pk_add_f32 v[18:19], v[18:19], v[58:59]
    v_pk_add_f32 v[20:21], v[20:21], v[60:61]
    v_pk_add_f32 v[22:23], v[22:23], v[62:63]
    v_pk_add_f32 v[24:25], v[24:25], v[64:65]
    v_pk_add_f32 v[26:27], v[26:27], v[66:67]
    s_add_u32 s34, s89, 3149824
    buffer_load_dwordx4 a[152:155], v2, s[4:7], s34 offen offset:0 sc1
    s_waitcnt lgkmcnt(6)
    v_pk_add_f32 v[16:17], v[16:17], v[68:69]
    v_pk_add_f32 v[18:19], v[18:19], v[70:71]
    v_pk_add_f32 v[20:21], v[20:21], v[72:73]
    v_pk_add_f32 v[22:23], v[22:23], v[74:75]
    v_pk_add_f32 v[24:25], v[24:25], v[76:77]
    v_pk_add_f32 v[26:27], v[26:27], v[78:79]
    s_add_u32 s34, s89, 3198976
    buffer_load_dwordx4 a[156:159], v2, s[4:7], s34 offen offset:0 sc1
    s_waitcnt lgkmcnt(3)
    v_pk_add_f32 v[16:17], v[16:17], v[80:81]
    v_pk_add_f32 v[18:19], v[18:19], v[82:83]
    v_pk_add_f32 v[20:21], v[20:21], v[84:85]
    v_pk_add_f32 v[22:23], v[22:23], v[86:87]
    v_pk_add_f32 v[24:25], v[24:25], v[88:89]
    v_pk_add_f32 v[26:27], v[26:27], v[90:91]
    s_add_u32 s34, s89, 3149824
    buffer_load_dwordx4 a[160:163], v2, s[4:7], s34 offen offset:1024 sc1
    s_waitcnt lgkmcnt(0)
    v_pk_add_f32 v[16:17], v[16:17], v[92:93]
    v_pk_add_f32 v[18:19], v[18:19], v[94:95]
    v_pk_add_f32 v[20:21], v[20:21], v[96:97]
    v_pk_add_f32 v[22:23], v[22:23], v[98:99]
    v_pk_add_f32 v[24:25], v[24:25], v[100:101]
    v_pk_add_f32 v[26:27], v[26:27], v[102:103]
    s_add_u32 s34, s89, 3198976
    buffer_load_dwordx4 a[164:167], v2, s[4:7], s34 offen offset:1024 sc1
    v_cvt_pk_bf16_f32 v104, v16, v17
    v_cvt_pk_bf16_f32 v105, v18, v19
    v_cvt_pk_bf16_f32 v106, v20, v21
    v_cvt_pk_bf16_f32 v107, v22, v23
    v_cvt_pk_bf16_f32 v108, v24, v25
    v_cvt_pk_bf16_f32 v109, v26, v27
gp_kernel_pHLj:
    ds_read_b64_tr_b16 v[112:113], v12 offset:0
    ds_read_b64_tr_b16 v[114:115], v13 offset:512
    ds_read_b64_tr_b16 v[116:117], v12 offset:1024
    s_waitcnt vmcnt(11)
    v_mfma_f32_16x16x32_bf16 v[16:19], v[124:127], a[120:123], 0
    s_add_u32 s34, s89, 3149824
    buffer_load_dwordx4 a[168:171], v2, s[4:7], s34 offen offset:2048 sc1
    v_mfma_f32_16x16x32_bf16 v[20:23], v[128:131], a[120:123], 0
    v_mfma_f32_16x16x32_bf16 v[24:27], v[132:135], a[120:123], 0
    v_mfma_f32_16x16x32_bf16 v[28:31], v[136:139], a[120:123], 0
    v_mfma_f32_16x16x32_bf16 v[32:35], v[140:143], a[120:123], 0
    s_waitcnt vmcnt(11)
    v_mfma_f32_16x16x32_bf16 v[36:39], v[124:127], a[124:127], 0
    s_add_u32 s34, s89, 3198976
    buffer_load_dwordx4 a[172:175], v2, s[4:7], s34 offen offset:2048 sc1
    v_mfma_f32_16x16x32_bf16 v[40:43], v[128:131], a[124:127], 0
    v_mfma_f32_16x16x32_bf16 v[44:47], v[132:135], a[124:127], 0
    v_mfma_f32_16x16x32_bf16 v[48:51], v[136:139], a[124:127], 0
    v_mfma_f32_16x16x32_bf16 v[52:55], v[140:143], a[124:127], 0
    s_waitcnt vmcnt(11)
    v_mfma_f32_16x16x32_bf16 v[16:19], v[144:147], a[128:131], v[16:19]
    s_add_u32 s34, s89, 3149824
    buffer_load_dwordx4 a[176:179], v2, s[4:7], s34 offen offset:3072 sc1
    v_mfma_f32_16x16x32_bf16 v[20:23], v[148:151], a[128:131], v[20:23]
    v_mfma_f32_16x16x32_bf16 v[24:27], v[152:155], a[128:131], v[24:27]
    v_mfma_f32_16x16x32_bf16 v[28:31], v[156:159], a[128:131], v[28:31]
    v_mfma_f32_16x16x32_bf16 v[32:35], v[160:163], a[128:131], v[32:35]
    s_waitcnt vmcnt(11)
    v_mfma_f32_16x16x32_bf16 v[36:39], v[144:147], a[132:135], v[36:39]
    s_add_u32 s34, s89, 3198976
    buffer_load_dwordx4 a[180:183], v2, s[4:7], s34 offen offset:3072 sc1
    v_mfma_f32_16x16x32_bf16 v[40:43], v[148:151], a[132:135], v[40:43]
    v_mfma_f32_16x16x32_bf16 v[44:47], v[152:155], a[132:135], v[44:47]
    v_mfma_f32_16x16x32_bf16 v[48:51], v[156:159], a[132:135], v[48:51]
    v_mfma_f32_16x16x32_bf16 v[52:55], v[160:163], a[132:135], v[52:55]
    s_waitcnt vmcnt(11)
    v_mfma_f32_16x16x32_bf16 v[16:19], v[164:167], a[136:139], v[16:19]
    s_add_u32 s34, s89, 3153920
    buffer_load_dwordx4 a[184:187], v2, s[4:7], s34 offen offset:0 sc1
    v_mfma_f32_16x16x32_bf16 v[20:23], v[168:171], a[136:139], v[20:23]
    v_mfma_f32_16x16x32_bf16 v[24:27], v[172:175], a[136:139], v[24:27]
    v_mfma_f32_16x16x32_bf16 v[28:31], v[176:179], a[136:139], v[28:31]
    v_mfma_f32_16x16x32_bf16 v[32:35], v[180:183], a[136:139], v[32:35]
    s_waitcnt vmcnt(11)
    v_mfma_f32_16x16x32_bf16 v[36:39], v[164:167], a[140:143], v[36:39]
    s_add_u32 s34, s89, 3203072
    buffer_load_dwordx4 a[188:191], v2, s[4:7], s34 offen offset:0 sc1
    v_mfma_f32_16x16x32_bf16 v[40:43], v[168:171], a[140:143], v[40:43]
    v_mfma_f32_16x16x32_bf16 v[44:47], v[172:175], a[140:143], v[44:47]
    v_mfma_f32_16x16x32_bf16 v[48:51], v[176:179], a[140:143], v[48:51]
    v_mfma_f32_16x16x32_bf16 v[52:55], v[180:183], a[140:143], v[52:55]
    s_waitcnt vmcnt(11)
    v_mfma_f32_16x16x32_bf16 v[16:19], v[184:187], a[144:147], v[16:19]
    s_add_u32 s34, s89, 3153920
    buffer_load_dwordx4 a[192:195], v2, s[4:7], s34 offen offset:1024 sc1
    v_mfma_f32_16x16x32_bf16 v[20:23], v[188:191], a[144:147], v[20:23]
    v_mfma_f32_16x16x32_bf16 v[24:27], v[192:195], a[144:147], v[24:27]
    v_mfma_f32_16x16x32_bf16 v[28:31], v[196:199], a[144:147], v[28:31]
    v_mfma_f32_16x16x32_bf16 v[32:35], v[200:203], a[144:147], v[32:35]
    s_waitcnt vmcnt(11)
    v_mfma_f32_16x16x32_bf16 v[36:39], v[184:187], a[148:151], v[36:39]
    s_add_u32 s34, s89, 3203072
    buffer_load_dwordx4 a[196:199], v2, s[4:7], s34 offen offset:1024 sc1
    v_mfma_f32_16x16x32_bf16 v[40:43], v[188:191], a[148:151], v[40:43]
    v_mfma_f32_16x16x32_bf16 v[44:47], v[192:195], a[148:151], v[44:47]
    v_mfma_f32_16x16x32_bf16 v[48:51], v[196:199], a[148:151], v[48:51]
    v_mfma_f32_16x16x32_bf16 v[52:55], v[200:203], a[148:151], v[52:55]
    s_waitcnt vmcnt(11)
    v_mfma_f32_16x16x32_bf16 v[16:19], v[204:207], a[152:155], v[16:19]
    s_add_u32 s34, s89, 3153920
    buffer_load_dwordx4 a[200:203], v2, s[4:7], s34 offen offset:2048 sc1
    v_mfma_f32_16x16x32_bf16 v[20:23], v[208:211], a[152:155], v[20:23]
    v_mfma_f32_16x16x32_bf16 v[24:27], v[212:215], a[152:155], v[24:27]
    v_mfma_f32_16x16x32_bf16 v[28:31], v[216:219], a[152:155], v[28:31]
    v_mfma_f32_16x16x32_bf16 v[32:35], v[220:223], a[152:155], v[32:35]
    s_waitcnt vmcnt(11)
    v_mfma_f32_16x16x32_bf16 v[36:39], v[204:207], a[156:159], v[36:39]
    s_add_u32 s34, s89, 3203072
    buffer_load_dwordx4 a[204:207], v2, s[4:7], s34 offen offset:2048 sc1
    v_mfma_f32_16x16x32_bf16 v[40:43], v[208:211], a[156:159], v[40:43]
    v_mfma_f32_16x16x32_bf16 v[44:47], v[212:215], a[156:159], v[44:47]
    v_mfma_f32_16x16x32_bf16 v[48:51], v[216:219], a[156:159], v[48:51]
    v_mfma_f32_16x16x32_bf16 v[52:55], v[220:223], a[156:159], v[52:55]
    s_waitcnt vmcnt(11)
    v_mfma_f32_16x16x32_bf16 v[16:19], v[224:227], a[160:163], v[16:19]
    s_add_u32 s34, s89, 3153920
    buffer_load_dwordx4 a[208:211], v2, s[4:7], s34 offen offset:3072 sc1
    v_mfma_f32_16x16x32_bf16 v[20:23], v[228:231], a[160:163], v[20:23]
    v_mfma_f32_16x16x32_bf16 v[24:27], v[232:235], a[160:163], v[24:27]
    v_mfma_f32_16x16x32_bf16 v[28:31], v[236:239], a[160:163], v[28:31]
    v_mfma_f32_16x16x32_bf16 v[32:35], v[240:243], a[160:163], v[32:35]
    s_waitcnt vmcnt(11)
    v_mfma_f32_16x16x32_bf16 v[36:39], v[224:227], a[164:167], v[36:39]
    s_add_u32 s34, s89, 3203072
    buffer_load_dwordx4 a[212:215], v2, s[4:7], s34 offen offset:3072 sc1
    v_mfma_f32_16x16x32_bf16 v[40:43], v[228:231], a[164:167], v[40:43]
    v_mfma_f32_16x16x32_bf16 v[44:47], v[232:235], a[164:167], v[44:47]
    v_mfma_f32_16x16x32_bf16 v[48:51], v[236:239], a[164:167], v[48:51]
    v_mfma_f32_16x16x32_bf16 v[52:55], v[240:243], a[164:167], v[52:55]
    s_waitcnt vmcnt(11)
    v_mfma_f32_16x16x32_bf16 v[16:19], a[0:3], a[168:171], v[16:19]
    buffer_store_dwordx4 v[104:107], v123, s[24:27], s92 offen
    buffer_store_dwordx2 v[108:109], v123, s[24:27], s92 offen offset:16
    v_mfma_f32_16x16x32_bf16 v[20:23], a[4:7], a[168:171], v[20:23]
    s_add_u32 s92, s92, 1310720
    v_mfma_f32_16x16x32_bf16 v[24:27], a[8:11], a[168:171], v[24:27]
    v_mfma_f32_16x16x32_bf16 v[28:31], a[12:15], a[168:171], v[28:31]
    v_mfma_f32_16x16x32_bf16 v[32:35], a[16:19], a[168:171], v[32:35]
    s_waitcnt vmcnt(12)
    v_mfma_f32_16x16x32_bf16 v[36:39], a[0:3], a[172:175], v[36:39]
    v_mfma_f32_16x16x32_bf16 v[40:43], a[4:7], a[172:175], v[40:43]
    v_mfma_f32_16x16x32_bf16 v[44:47], a[8:11], a[172:175], v[44:47]
    v_mfma_f32_16x16x32_bf16 v[48:51], a[12:15], a[172:175], v[48:51]
    v_mfma_f32_16x16x32_bf16 v[52:55], a[16:19], a[172:175], v[52:55]
    s_waitcnt vmcnt(11)
    v_mfma_f32_16x16x32_bf16 v[16:19], a[20:23], a[176:179], v[16:19]
    v_mfma_f32_16x16x32_bf16 v[20:23], a[24:27], a[176:179], v[20:23]
    v_mfma_f32_16x16x32_bf16 v[24:27], a[28:31], a[176:179], v[24:27]
    v_mfma_f32_16x16x32_bf16 v[28:31], a[32:35], a[176:179], v[28:31]
    v_mfma_f32_16x16x32_bf16 v[32:35], a[36:39], a[176:179], v[32:35]
    s_waitcnt vmcnt(10)
    v_mfma_f32_16x16x32_bf16 v[36:39], a[20:23], a[180:183], v[36:39]
    v_mfma_f32_16x16x32_bf16 v[40:43], a[24:27], a[180:183], v[40:43]
    v_mfma_f32_16x16x32_bf16 v[44:47], a[28:31], a[180:183], v[44:47]
    v_mfma_f32_16x16x32_bf16 v[48:51], a[32:35], a[180:183], v[48:51]
    v_mfma_f32_16x16x32_bf16 v[52:55], a[36:39], a[180:183], v[52:55]
    s_waitcnt vmcnt(9)
    v_mfma_f32_16x16x32_bf16 v[16:19], a[40:43], a[184:187], v[16:19]
    v_mfma_f32_16x16x32_bf16 v[20:23], a[44:47], a[184:187], v[20:23]
    v_mfma_f32_16x16x32_bf16 v[24:27], a[48:51], a[184:187], v[24:27]
    v_mfma_f32_16x16x32_bf16 v[28:31], a[52:55], a[184:187], v[28:31]
    v_mfma_f32_16x16x32_bf16 v[32:35], a[56:59], a[184:187], v[32:35]
    s_waitcnt vmcnt(8)
    v_mfma_f32_16x16x32_bf16 v[36:39], a[40:43], a[188:191], v[36:39]
    v_mfma_f32_16x16x32_bf16 v[40:43], a[44:47], a[188:191], v[40:43]
    v_mfma_f32_16x16x32_bf16 v[44:47], a[48:51], a[188:191], v[44:47]
    v_mfma_f32_16x16x32_bf16 v[48:51], a[52:55], a[188:191], v[48:51]
    v_mfma_f32_16x16x32_bf16 v[52:55], a[56:59], a[188:191], v[52:55]
    s_waitcnt vmcnt(7)
    v_mfma_f32_16x16x32_bf16 v[16:19], a[60:63], a[192:195], v[16:19]
    v_mfma_f32_16x16x32_bf16 v[20:23], a[64:67], a[192:195], v[20:23]
    v_mfma_f32_16x16x32_bf16 v[24:27], a[68:71], a[192:195], v[24:27]
    v_mfma_f32_16x16x32_bf16 v[28:31], a[72:75], a[192:195], v[28:31]
    v_mfma_f32_16x16x32_bf16 v[32:35], a[76:79], a[192:195], v[32:35]
    s_waitcnt vmcnt(6)
    v_mfma_f32_16x16x32_bf16 v[36:39], a[60:63], a[196:199], v[36:39]
    v_mfma_f32_16x16x32_bf16 v[40:43], a[64:67], a[196:199], v[40:43]
    v_mfma_f32_16x16x32_bf16 v[44:47], a[68:71], a[196:199], v[44:47]
    v_mfma_f32_16x16x32_bf16 v[48:51], a[72:75], a[196:199], v[48:51]
    v_mfma_f32_16x16x32_bf16 v[52:55], a[76:79], a[196:199], v[52:55]
    s_waitcnt vmcnt(5)
    v_mfma_f32_16x16x32_bf16 v[16:19], a[80:83], a[200:203], v[16:19]
    v_mfma_f32_16x16x32_bf16 v[20:23], a[84:87], a[200:203], v[20:23]
    v_mfma_f32_16x16x32_bf16 v[24:27], a[88:91], a[200:203], v[24:27]
    v_mfma_f32_16x16x32_bf16 v[28:31], a[92:95], a[200:203], v[28:31]
    v_mfma_f32_16x16x32_bf16 v[32:35], a[96:99], a[200:203], v[32:35]
    s_waitcnt vmcnt(3)
    v_mfma_f32_16x16x32_bf16 v[16:19], a[100:103], a[208:211], v[16:19]
    v_mfma_f32_16x16x32_bf16 v[20:23], a[104:107], a[208:211], v[20:23]
    v_mfma_f32_16x16x32_bf16 v[24:27], a[108:111], a[208:211], v[24:27]
    v_mfma_f32_16x16x32_bf16 v[28:31], a[112:115], a[208:211], v[28:31]
    v_mfma_f32_16x16x32_bf16 v[32:35], a[116:119], a[208:211], v[32:35]
    v_mfma_f32_16x16x32_bf16 v[36:39], a[80:83], a[204:207], v[36:39]
    v_mfma_f32_16x16x32_bf16 v[40:43], a[84:87], a[204:207], v[40:43]
    v_mfma_f32_16x16x32_bf16 v[44:47], a[88:91], a[204:207], v[44:47]
    v_mfma_f32_16x16x32_bf16 v[48:51], a[92:95], a[204:207], v[48:51]
    ds_write_b128 v4, v[16:19] offset:40960
    v_mfma_f32_16x16x32_bf16 v[52:55], a[96:99], a[204:207], v[52:55]
    ds_write_b128 v4, v[20:23] offset:41984
    s_waitcnt vmcnt(2)
    v_mfma_f32_16x16x32_bf16 v[36:39], a[100:103], a[212:215], v[36:39]
    ds_write_b128 v4, v[24:27] offset:43008
    v_mfma_f32_16x16x32_bf16 v[40:43], a[104:107], a[212:215], v[40:43]
    ds_write_b128 v4, v[28:31] offset:44032
    v_mfma_f32_16x16x32_bf16 v[44:47], a[108:111], a[212:215], v[44:47]
    ds_write_b128 v4, v[32:35] offset:45056
    v_mfma_f32_16x16x32_bf16 v[48:51], a[112:115], a[212:215], v[48:51]
    v_mfma_f32_16x16x32_bf16 v[52:55], a[116:119], a[212:215], v[52:55]
    s_nop 3
    ds_write_b128 v4, v[36:39] offset:46080
    ds_write_b128 v4, v[40:43] offset:47104
    ds_write_b128 v4, v[44:47] offset:48128
    ds_write_b128 v4, v[48:51] offset:49152
    ds_write_b128 v4, v[52:55] offset:50176
    s_waitcnt lgkmcnt(0)
    s_barrier
    ds_read_b128 v[56:59], v6 offset:0
    ds_read_b128 v[60:63], v6 offset:1024
    ds_read_b128 v[64:67], v6 offset:2048
    ds_read_b128 v[68:71], v6 offset:10240
    ds_read_b128 v[72:75], v6 offset:11264
    ds_read_b128 v[76:79], v6 offset:12288
    ds_read_b128 v[80:83], v6 offset:20480
    ds_read_b128 v[84:87], v6 offset:21504
    ds_read_b128 v[88:91], v6 offset:22528
    ds_read_b128 v[92:95], v6 offset:30720
    ds_read_b128 v[96:99], v6 offset:31744
    ds_read_b128 v[100:103], v6 offset:32768
    v_lshlrev_b32 v16, 16, v112
    v_and_b32 v17, s29, v112
    v_lshlrev_b32 v18, 16, v113
    v_and_b32 v19, s29, v113
    v_lshlrev_b32 v20, 16, v114
    v_and_b32 v21, s29, v114
    v_lshlrev_b32 v22, 16, v115
    v_and_b32 v23, s29, v115
    v_lshlrev_b32 v24, 16, v116
    v_and_b32 v25, s29, v116
    v_lshlrev_b32 v26, 16, v117
    v_and_b32 v27, s29, v117
    s_waitcnt lgkmcnt(9)
    v_pk_add_f32 v[16:17], v[16:17], v[56:57]
    v_pk_add_f32 v[18:19], v[18:19], v[58:59]
    v_pk_add_f32 v[20:21], v[20:21], v[60:61]
    v_pk_add_f32 v[22:23], v[22:23], v[62:63]
    v_pk_add_f32 v[24:25], v[24:25], v[64:65]
    v_pk_add_f32 v[26:27], v[26:27], v[66:67]
    s_waitcnt lgkmcnt(6)
    v_pk_add_f32 v[16:17], v[16:17], v[68:69]
    v_pk_add_f32 v[18:19], v[18:19], v[70:71]
    v_pk_add_f32 v[20:21], v[20:21], v[72:73]
    v_pk_add_f32 v[22:23], v[22:23], v[74:75]
    v_pk_add_f32 v[24:25], v[24:25], v[76:77]
    v_pk_add_f32 v[26:27], v[26:27], v[78:79]
    s_waitcnt lgkmcnt(3)
    v_pk_add_f32 v[16:17], v[16:17], v[80:81]
    v_pk_add_f32 v[18:19], v[18:19], v[82:83]
    v_pk_add_f32 v[20:21], v[20:21], v[84:85]
    v_pk_add_f32 v[22:23], v[22:23], v[86:87]
    v_pk_add_f32 v[24:25], v[24:25], v[88:89]
    v_pk_add_f32 v[26:27], v[26:27], v[90:91]
    s_waitcnt lgkmcnt(0)
    v_pk_add_f32 v[16:17], v[16:17], v[92:93]
    v_pk_add_f32 v[18:19], v[18:19], v[94:95]
    v_pk_add_f32 v[20:21], v[20:21], v[96:97]
    v_pk_add_f32 v[22:23], v[22:23], v[98:99]
    v_pk_add_f32 v[24:25], v[24:25], v[100:101]
    v_pk_add_f32 v[26:27], v[26:27], v[102:103]
    v_cvt_pk_bf16_f32 v104, v16, v17
    v_cvt_pk_bf16_f32 v105, v18, v19
    v_cvt_pk_bf16_f32 v106, v20, v21
    v_cvt_pk_bf16_f32 v107, v22, v23
    v_cvt_pk_bf16_f32 v108, v24, v25
    v_cvt_pk_bf16_f32 v109, v26, v27
    buffer_store_dwordx4 v[104:107], v123, s[24:27], s92 offen
    buffer_store_dwordx2 v[108:109], v123, s[24:27], s92 offen offset:16
gp_kernel_end:
    s_endpgm
gp_kernel_FLs:
    s_mov_b32 s96, 0
gp_kernel_FLl:
    s_add_u32 s96, s96, 1
    buffer_load_dword v119, v11, s[4:7], s87 offen sc1
    s_waitcnt vmcnt(0)
    v_cmp_ne_u32 vcc, s28, v119
    s_nop 4
    s_cbranch_vccz gp_kernel_FLd
    s_cmp_lt_u32 s96, 40000
    s_cbranch_scc1 gp_kernel_FLl
    s_branch gp_kernel_FLd
gp_kernel_HEs:
    s_mov_b32 s96, 0
gp_kernel_HEl:
    s_add_u32 s96, s96, 1
    buffer_load_dword v119, v122, s[4:7], s86 offen sc1
    s_waitcnt vmcnt(0)
    v_cmp_ne_u32 vcc, s28, v119
    s_nop 4
    s_cbranch_vccz gp_kernel_HEd
    s_cmp_lt_u32 s96, 40000
    s_cbranch_scc1 gp_kernel_HEl
    s_branch gp_kernel_HEd
gp_kernel_pHLs:
    s_waitcnt lgkmcnt(9)
    v_pk_add_f32 v[16:17], v[16:17], v[56:57]
    v_pk_add_f32 v[18:19], v[18:19], v[58:59]
    v_pk_add_f32 v[20:21], v[20:21], v[60:61]
    v_pk_add_f32 v[22:23], v[22:23], v[62:63]
    v_pk_add_f32 v[24:25], v[24:25], v[64:65]
    v_pk_add_f32 v[26:27], v[26:27], v[66:67]
    s_waitcnt lgkmcnt(6)
    v_pk_add_f32 v[16:17], v[16:17], v[68:69]
    v_pk_add_f32 v[18:19], v[18:19], v[70:71]
    v_pk_add_f32 v[20:21], v[20:21], v[72:73]
    v_pk_add_f32 v[22:23], v[22:23], v[74:75]
    v_pk_add_f32 v[24:25], v[24:25], v[76:77]
    v_pk_add_f32 v[26:27], v[26:27], v[78:79]
    s_waitcnt lgkmcnt(3)
    v_pk_add_f32 v[16:17], v[16:17], v[80:81]
    v_pk_add_f32 v[18:19], v[18:19], v[82:83]
    v_pk_add_f32 v[20:21], v[20:21], v[84:85]
    v_pk_add_f32 v[22:23], v[22:23], v[86:87]
    v_pk_add_f32 v[24:25], v[24:25], v[88:89]
    v_pk_add_f32 v[26:27], v[26:27], v[90:91]
    s_waitcnt lgkmcnt(0)
    v_pk_add_f32 v[16:17], v[16:17], v[92:93]
    v_pk_add_f32 v[18:19], v[18:19], v[94:95]
    v_pk_add_f32 v[20:21], v[20:21], v[96:97]
    v_pk_add_f32 v[22:23], v[22:23], v[98:99]
    v_pk_add_f32 v[24:25], v[24:25], v[100:101]
    v_pk_add_f32 v[26:27], v[26:27], v[102:103]
    v_cvt_pk_bf16_f32 v104, v16, v17
    v_cvt_pk_bf16_f32 v105, v18, v19
    v_cvt_pk_bf16_f32 v106, v20, v21
    v_cvt_pk_bf16_f32 v107, v22, v23
    v_cvt_pk_bf16_f32 v108, v24, v25
    v_cvt_pk_bf16_f32 v109, v26, v27
    s_mov_b32 s96, 0
gp_kernel_pHL:
    s_add_u32 s96, s96, 1
    buffer_load_dword v110, v122, s[4:7], s86 offen sc1
    s_waitcnt vmcnt(0)
    v_cmp_ne_u32 vcc, s28, v110
    s_nop 4
    s_cbranch_vccz gp_kernel_pHLd
    s_cmp_lt_u32 s96, 40000
    s_cbranch_scc1 gp_kernel_pHL
gp_kernel_pHLd:
    s_add_u32 s34, s89, 3145728
    buffer_load_dwordx4 a[120:123], v2, s[4:7], s34 offen offset:0 sc1
    s_add_u32 s34, s89, 3194880
    buffer_load_dwordx4 a[124:127], v2, s[4:7], s34 offen offset:0 sc1
    s_add_u32 s34, s89, 3145728
    buffer_load_dwordx4 a[128:131], v2, s[4:7], s34 offen offset:1024 sc1
    s_add_u32 s34, s89, 3194880
    buffer_load_dwordx4 a[132:135], v2, s[4:7], s34 offen offset:1024 sc1
    s_add_u32 s34, s89, 3145728
    buffer_load_dwordx4 a[136:139], v2, s[4:7], s34 offen offset:2048 sc1
    s_add_u32 s34, s89, 3194880
    buffer_load_dwordx4 a[140:143], v2, s[4:7], s34 offen offset:2048 sc1
    s_add_u32 s34, s89, 3145728
    buffer_load_dwordx4 a[144:147], v2, s[4:7], s34 offen offset:3072 sc1
    s_add_u32 s34, s89, 3194880
    buffer_load_dwordx4 a[148:151], v2, s[4:7], s34 offen offset:3072 sc1
    s_add_u32 s34, s89, 3149824
    buffer_load_dwordx4 a[152:155], v2, s[4:7], s34 offen offset:0 sc1
    s_add_u32 s34, s89, 3198976
    buffer_load_dwordx4 a[156:159], v2, s[4:7], s34 offen offset:0 sc1
    s_add_u32 s34, s89, 3149824
    buffer_load_dwordx4 a[160:163], v2, s[4:7], s34 offen offset:1024 sc1
    s_add_u32 s34, s89, 3198976
    buffer_load_dwordx4 a[164:167], v2, s[4:7], s34 offen offset:1024 sc1
    s_branch gp_kernel_pHLj
.section .rodata,"a"
.p2align 6
.amdhsa_kernel gp_kernel
  .amdhsa_next_free_vgpr 512
  .amdhsa_next_free_sgpr 102
  .amdhsa_accum_offset 256
  .amdhsa_group_segment_fixed_size 0
  .amdhsa_kernarg_size 104
  .amdhsa_user_sgpr_count 2
  .amdhsa_user_sgpr_kernarg_segment_ptr 1
  .amdhsa_system_sgpr_workgroup_id_x 1
.end_amdhsa_kernel
```
